```python
import torch

def _softmax(x, axis=-1):
    return torch.softmax(x, dim=axis)

def _gelu(x):
    return torch.nn.functional.gelu(x, approximate='tanh')

def _silu(x):
    return torch.nn.functional.silu(x)

def _sigmoid(x):
    return torch.sigmoid(x)

def _layernorm(x, axis=-1, eps=1e-05):
    m = x.mean(dim=axis, keepdim=True)
    v = x.var(dim=axis, keepdim=True, unbiased=False)
    return (x - m) / torch.sqrt(v + eps)

def _scatter_add(tgt, idx, src, axis=0):
    return tgt.clone().index_add_(axis, idx, src)

def _segment_sum(src, seg, n):
    out = torch.zeros((n,) + src.shape[1:], dtype=src.dtype)
    return out.index_add_(0, seg, src)

def _pad(x, pw):
    flat = tuple((v for pair in reversed(pw) for v in pair))
    return torch.nn.functional.pad(x, flat)
kernel_name = 'standalone__conformer_conv_module__speech'

def setup_inputs():

    _w = lambda a: (lambda t: t.to(torch.bfloat16) if t.is_floating_point() else t)(torch.as_tensor(a))
    B, T, D, K = (2, 4000, 512, 31)
    return {'x': _w((lambda *s: torch.randn(*s, dtype=torch.bfloat16) * 0.2)(B, T, D)), 'w_pw1': _w((lambda *s: torch.randn(*s, dtype=torch.bfloat16) * 0.2)(D, 2 * D)), 'dw': _w((lambda *s: torch.randn(*s, dtype=torch.bfloat16) * 0.2)(K, D)), 'w_pw2': _w((lambda *s: torch.randn(*s, dtype=torch.bfloat16) * 0.05)(D, D))}

def reference(x, w_pw1, dw, w_pw2):
    B, T, D = x.shape
    K = dw.shape[0]
    h = x @ w_pw1
    a, b = (h[..., :D].clone(), h[..., D:].clone())
    h = a * _sigmoid(b)
    pad = K // 2
    hp = _pad(h, ((0, 0), (pad, pad), (0, 0)))
    out = torch.zeros_like(h)
    for i in range(K):
        out = out + hp[:, i:i + T, :] * dw[i][None, None, :]
    return _silu(out) @ w_pw2
```

```asm
; @launch grid=(256,1,1) block=(512,1,1) lds=163840
.amdgcn_target "amdgcn-amd-amdhsa--gfx950"
.text
.globl standalone__conformer_conv_module__speech_kernel
.p2align 8
.type standalone__conformer_conv_module__speech_kernel,@function
standalone__conformer_conv_module__speech_kernel:
    s_cmp_ge_u32 s2, 256
    s_cbranch_scc1 L_end
    s_load_dwordx8 s[32:39], s[0:1], 0
    s_load_dwordx4 s[40:43], s[0:1], 32
    s_load_dwordx2 s[44:45], s[0:1], 48
    v_lshrrev_b32 v2, 6, v0
    v_and_b32 v1, 63, v0
    s_lshr_b32 s71, s2, 3
    v_readfirstlane_b32 s7, v2
    s_and_b32 s53, s2, 7
    s_lshr_b32 s46, s71, 3
    s_and_b32 s47, s71, 7
    s_lshl_b32 s5, s53, 2
    s_lshl_b32 s6, s46, 1
    s_add_u32 s53, s53, s6
    s_add_u32 s53, s53, s47
    s_and_b32 s53, s53, 7
    s_add_u32 s46, s46, s5
    s_lshr_b32 s48, s46, 4
    s_and_b32 s49, s46, 15
    s_mul_i32 s50, s49, 250
    s_sub_u32 s50, s50, 16
    s_and_b32 s4, s7, 3
    s_lshl_b32 s51, s4, 10
    v_and_b32 v2, 15, v1
    v_lshrrev_b32 v3, 4, v1
    s_cmp_lt_u32 s7, 4
    s_cbranch_scc1 L_C
    v_mov_b32 v35, 0x80000000
    v_lshrrev_b32 v32, 1, v1
    v_subrev_u32 v32, 8, v32
    v_and_b32 v33, 1, v1
    v_lshlrev_b32 v33, 4, v33
    s_lshl_b32 s5, s47, 7
    s_lshl_b32 s6, s4, 5
    s_add_u32 s6, s5, s6
    v_add_u32 v33, s6, v33
    v_lshl_add_u32 v33, v32, 10, v33
    v_cmp_gt_i32 vcc, 0, v32
    v_add_u32 v37, 32768, v33
    s_lshr_b32 s6, s4, 1
    s_lshl_b32 s6, s6, 2
    v_or_b32 v32, s6, v3
    v_lshlrev_b32 v32, 1, v32
    v_cndmask_b32 v36, v33, v35, vcc
    v_xor_b32 v32, v32, v2
    v_and_b32 v33, 7, v32
    v_lshlrev_b32 v33, 4, v33
    v_lshrrev_b32 v32, 3, v32
    v_lshl_add_u32 v33, v32, 10, v33
    s_lshl_b32 s6, s4, 2
    v_add_u32 v32, s6, v3
    v_lshl_add_u32 v33, v32, 11, v33
    v_add_u32 v13, s5, v33
    v_add_u32 v14, 32768, v13
    v_add_u32 v15, 65536, v13
    v_add_u32 v16, 98304, v13
    v_lshrrev_b32 v32, 3, v1
    s_lshl_b32 s5, s4, 3
    v_add_u32 v32, s5, v32
    v_and_b32 v33, 1, v3
    s_lshl_b32 s6, s4, 1
    v_or_b32 v33, s6, v33
    v_xor_b32 v33, v33, v1
    v_and_b32 v33, 7, v33
    v_add_u32 v32, s50, v32
    v_lshlrev_b32 v34, 10, v32
    v_lshl_add_u32 v34, v33, 4, v34
    v_cmp_gt_i32 vcc, 0, v32
    v_add_u32 v5, 32768, v34
    v_add_u32 v6, 65536, v34
    v_cndmask_b32 v4, v34, v35, vcc
    s_lshl_b32 s54, s53, 7
    s_lshl_b32 s62, s53, 17
    s_mul_i32 s5, s48, 4096000
    s_waitcnt lgkmcnt(0)
    s_mov_b32 s16, s36
    s_and_b32 s17, s37, 0xffff
    s_mov_b32 s18, 31744
    s_mov_b32 s19, 0x20000
    buffer_load_dwordx4 v[104:107], v36, s[16:19], 0 offen
    buffer_load_dwordx4 v[108:111], v37, s[16:19], 0 offen
    s_mov_b32 s12, s34
    s_and_b32 s13, s35, 0xffff
    s_mov_b32 s14, 1048576
    s_mov_b32 s15, 0x20000
    s_add_u32 s8, s32, s5
    s_addc_u32 s9, s33, 0
    s_and_b32 s9, s9, 0xffff
    s_mov_b32 s10, 4096000
    s_mov_b32 s11, 0x20000
    s_add_u32 m0, s51, 49152
    s_nop 0
    buffer_load_dwordx4 v13, s[12:15], s62 offen lds
    s_add_u32 m0, s51, 53248
    s_nop 0
    buffer_load_dwordx4 v14, s[12:15], s62 offen lds
    s_add_u32 m0, s51, 57344
    s_nop 0
    buffer_load_dwordx4 v15, s[12:15], s62 offen lds
    s_add_u32 m0, s51, 61440
    s_nop 0
    buffer_load_dwordx4 v16, s[12:15], s62 offen lds
    s_add_u32 m0, s51, 32768
    s_nop 0
    buffer_load_dwordx4 v4, s[8:11], s54 offen lds
    s_add_u32 m0, s51, 36864
    s_nop 0
    buffer_load_dwordx4 v5, s[8:11], s54 offen lds
    s_add_u32 m0, s51, 40960
    s_nop 0
    buffer_load_dwordx4 v6, s[8:11], s54 offen lds
    s_add_u32 s5, s53, 1
    s_and_b32 s5, s5, 7
    s_lshl_b32 s55, s5, 7
    s_lshl_b32 s63, s5, 17
    s_add_u32 s5, s53, 2
    s_and_b32 s5, s5, 7
    s_lshl_b32 s56, s5, 7
    s_lshl_b32 s64, s5, 17
    s_add_u32 s5, s53, 3
    s_and_b32 s5, s5, 7
    s_lshl_b32 s57, s5, 7
    s_lshl_b32 s65, s5, 17
    s_add_u32 s5, s53, 4
    s_and_b32 s5, s5, 7
    s_lshl_b32 s58, s5, 7
    s_lshl_b32 s66, s5, 17
    s_add_u32 s5, s53, 5
    s_and_b32 s5, s5, 7
    s_lshl_b32 s59, s5, 7
    s_lshl_b32 s67, s5, 17
    s_add_u32 s5, s53, 6
    s_and_b32 s5, s5, 7
    s_lshl_b32 s60, s5, 7
    s_lshl_b32 s68, s5, 17
    s_add_u32 s5, s53, 7
    s_and_b32 s5, s5, 7
    s_lshl_b32 s61, s5, 7
    s_lshl_b32 s69, s5, 17
    v_add_u32 v7, 98304, v34
    v_add_u32 v8, 131072, v34
    v_add_u32 v9, 163840, v34
    v_add_u32 v10, 196608, v34
    v_add_u32 v11, 229376, v34
    v_add_u32 v12, 262144, v34
    s_mov_b32 s20, s44
    s_and_b32 s21, s45, 0xffff
    s_mov_b32 s22, 8454144
    s_mov_b32 s23, 0x20000
    s_mov_b32 s24, s38
    s_and_b32 s25, s39, 0xffff
    s_mov_b32 s26, 524288
    s_mov_b32 s27, 0x20000
    v_mov_b32 v30, 0
    s_lshl_b32 s5, s46, 11
    s_add_u32 s5, s5, 8388608
    v_lshrrev_b32 v32, 2, v1
    v_lshlrev_b32 v32, 7, v32
    v_and_b32 v33, 3, v1
    v_lshl_add_u32 v32, v33, 2, v32
    v_add_u32 v29, s5, v32
    s_or_b32 s5, s47, s4
    s_cmp_lg_u32 s5, 0
    s_cbranch_scc1 L_noclear
    buffer_store_dword v30, v29, s[20:23], 0 offen sc0 sc1
L_noclear:
    s_lshl_b32 s5, s47, 2
    s_add_u32 s5, s5, s4
    s_lshl_b32 s49, 1, s5
    s_add_u32 s5, s5, s50
    s_add_u32 s5, s5, 96
    s_lshl_b32 s5, s5, 10
    v_lshrrev_b32 v32, 3, v1
    v_lshlrev_b32 v32, 15, v32
    v_and_b32 v33, 7, v1
    v_lshl_add_u32 v32, v33, 7, v32
    v_add_u32 v25, s5, v32
    s_lshl_b32 s5, s71, 2
    s_add_u32 s5, s5, s4
    s_lshl_b32 s5, s5, 12
    v_lshlrev_b32 v32, 7, v1
    v_add_u32 v26, s5, v32
    s_add_u32 m0, s51, 81920
    s_nop 0
    buffer_load_dwordx4 v13, s[12:15], s63 offen lds
    s_add_u32 m0, s51, 86016
    s_nop 0
    buffer_load_dwordx4 v14, s[12:15], s63 offen lds
    s_add_u32 m0, s51, 90112
    s_nop 0
    buffer_load_dwordx4 v15, s[12:15], s63 offen lds
    s_add_u32 m0, s51, 94208
    s_nop 0
    buffer_load_dwordx4 v16, s[12:15], s63 offen lds
    s_mov_b32 exec_lo, 0xffff
    s_mov_b32 exec_hi, 0x0
    buffer_load_dword v27, v25, s[8:11], 0 offen
    s_mov_b64 exec, -1
    s_mov_b32 s72, 0xbfb8aa3b
    s_mov_b32 s73, 0xbfb8aa3b
    s_mul_i32 s3, s4, 7424
    s_add_u32 s52, s3, 3072
    s_lshl_b32 s5, s47, 3
    s_lshl_b32 s6, s4, 1
    s_add_u32 s5, s5, s6
    s_lshl_b32 s5, s5, 17
    s_lshl_b32 s6, s46, 12
    s_add_u32 s5, s5, s6
    v_lshrrev_b32 v32, 3, v2
    v_lshlrev_b32 v32, 17, v32
    v_lshl_add_u32 v32, v3, 7, v32
    v_and_b32 v33, 7, v2
    v_lshl_add_u32 v32, v33, 4, v32
    v_add_u32 v18, s5, v32
    s_lshr_b32 s5, s47, 2
    s_lshl_b32 s5, s5, 10
    s_add_u32 s5, s5, s6
    s_lshl_b32 s6, s4, 17
    s_add_u32 s5, s5, s6
    v_lshlrev_b32 v32, 4, v1
    v_add_u32 v124, s5, v32
    v_lshrrev_b32 v32, 3, v1
    v_lshlrev_b32 v32, 19, v32
    v_and_b32 v33, 7, v1
    v_lshl_add_u32 v32, v33, 7, v32
    v_add_u32 v17, s5, v32
    s_lshl_b32 s5, s46, 3
    v_mov_b32 v28, s5
    v_mov_b32 v30, 1
    s_lshl_b32 s5, s4, 3
    v_add_u32 v32, s5, v3
    v_xor_b32 v33, v2, v3
    v_lshlrev_b32 v33, 4, v33
    v_lshl_add_u32 v126, v32, 8, v33
    s_lshr_b32 s5, s47, 2
    s_lshl_b32 s5, s5, 6
    v_add_u32 v32, s5, v32
    s_mul_i32 s5, s48, 4000
    s_add_u32 s5, s5, s50
    s_add_u32 s5, s5, 16
    v_add_u32 v32, s5, v32
    s_and_b32 s6, s47, 3
    s_lshl_b32 s6, s6, 8
    v_lshlrev_b32 v33, 4, v2
    v_add_u32 v33, s6, v33
    v_lshl_add_u32 v127, v32, 10, v33
    s_add_u32 s5, s5, 250
    s_lshl_b32 s52, s5, 10
    s_mov_b32 s28, s40
    s_and_b32 s29, s41, 0xffff
    s_mov_b32 s30, s52
    s_mov_b32 s31, 0x20000
    s_add_u32 s52, s3, 3072
    s_and_b32 s6, s47, 3
    s_add_u32 s5, s6, 0
    s_and_b32 s5, s5, 3
    s_lshl_b32 s32, s5, 17
    s_lshl_b32 s36, s5, 21
    s_add_u32 s5, s6, 1
    s_and_b32 s5, s5, 3
    s_lshl_b32 s33, s5, 17
    s_lshl_b32 s37, s5, 21
    s_add_u32 s5, s6, 2
    s_and_b32 s5, s5, 3
    s_lshl_b32 s34, s5, 17
    s_lshl_b32 s38, s5, 21
    s_add_u32 s5, s6, 3
    s_and_b32 s5, s5, 3
    s_lshl_b32 s35, s5, 17
    s_lshl_b32 s39, s5, 21
    v_and_b32 v32, 3, v2
    v_lshlrev_b32 v32, 2, v32
    v_lshrrev_b32 v33, 2, v2
    v_or_b32 v32, v32, v33
    v_lshlrev_b32 v32, 3, v32
    v_lshl_add_u32 v19, v3, 3, v32
    v_subrev_u32 v20, 8, v19
    v_add_u32 v33, 32, v32
    v_cmp_eq_u32 vcc, 0, v3
    v_lshl_add_u32 v21, v3, 2, v32
    v_add_u32 v21, 24, v21
    v_cndmask_b32 v20, v20, v33, vcc
    v_mov_b32 v33, 3712
    v_mov_b32 v34, 0
    v_cndmask_b32 v33, v33, v34, vcc
    v_lshl_add_u32 v19, v19, 1, s3
    v_lshl_add_u32 v20, v20, 1, v33
    v_add_u32 v20, s3, v20
    v_lshl_add_u32 v21, v21, 1, s3
    v_add_u32 v21, 3712, v21
    v_and_b32 v32, 3, v2
    v_lshlrev_b32 v32, 2, v32
    v_lshrrev_b32 v33, 2, v2
    v_or_b32 v32, v32, v33
    v_lshlrev_b32 v32, 3, v32
    v_add_u32 v32, 128, v32
    v_lshl_add_u32 v22, v3, 3, v32
    v_subrev_u32 v23, 8, v22
    v_add_u32 v33, 32, v32
    v_cmp_eq_u32 vcc, 0, v3
    v_lshl_add_u32 v24, v3, 2, v32
    v_add_u32 v24, 24, v24
    v_cndmask_b32 v23, v23, v33, vcc
    v_mov_b32 v33, 3712
    v_mov_b32 v34, 0
    v_cndmask_b32 v33, v33, v34, vcc
    v_subrev_u32 v34, 224, v22
    v_min_u32 v22, v34, v22
    v_subrev_u32 v34, 224, v23
    v_min_u32 v23, v34, v23
    v_subrev_u32 v34, 224, v24
    v_min_u32 v24, v34, v24
    v_lshl_add_u32 v22, v22, 1, s3
    v_lshl_add_u32 v23, v23, 1, v33
    v_add_u32 v23, s3, v23
    v_lshl_add_u32 v24, v24, 1, s3
    v_add_u32 v24, 3712, v24
    v_lshl_add_u32 v38, v1, 4, s3
    v_lshl_add_u32 v39, v1, 3, s3
    v_mul_u32_u24 v40, 80, v2
    v_lshl_add_u32 v40, v3, 3, v40
    v_add_u32 v40, s52, v40
    v_and_b32 v42, 6, v2
    v_lshlrev_b32 v42, 1, v42
    v_sub_u32 v42, 1324, v42
    v_and_b32 v43, 1, v2
    v_mul_u32_u24 v43, 1312, v43
    v_sub_u32 v42, v42, v43
    v_add_u32 v42, s52, v42
    v_mov_b32 v43, s52
    v_lshl_add_u32 v44, v3, 4, v42
    v_cmp_gt_u32 vcc, 8, v2
    v_lshl_add_u32 v46, v3, 3, v42
    v_add_u32 v46, 688, v46
    v_add_u32 v41, 624, v44
    v_add_u32 v47, 64, v42
    v_cndmask_b32 v44, v43, v44, vcc
    v_cndmask_b32 v46, v46, v43, vcc
    v_cndmask_b32 v41, v41, v43, vcc
    v_cndmask_b32 v47, v43, v47, vcc
    v_cmp_eq_u32 vcc, 0, v3
    s_nop 1
    v_cndmask_b32 v45, v41, v47, vcc
    s_waitcnt vmcnt(13)
    ds_write_b128 v38, v[104:107] offset:0
    s_waitcnt vmcnt(12)
    ds_write_b128 v38, v[108:111] offset:1024
    ds_read_b64_tr_b16 v[116:117], v39 offset:1024
    ds_read_b64_tr_b16 v[112:113], v39 offset:0
    ds_read_b64_tr_b16 v[114:115], v39 offset:512
    ds_read_b64_tr_b16 v[122:123], v39 offset:1056
    ds_read_b64_tr_b16 v[118:119], v39 offset:32
    ds_read_b64_tr_b16 v[120:121], v39 offset:544
    s_waitcnt lgkmcnt(5)
    ds_write_b64 v40, v[116:117] offset:64
    s_waitcnt lgkmcnt(5)
    ds_write_b64 v40, v[112:113] offset:0
    s_waitcnt lgkmcnt(5)
    ds_write_b64 v40, v[114:115] offset:32
    s_waitcnt lgkmcnt(5)
    ds_write_b64 v40, v[122:123] offset:1376
    s_waitcnt lgkmcnt(5)
    ds_write_b64 v40, v[118:119] offset:1312
    s_waitcnt lgkmcnt(5)
    ds_write_b64 v40, v[120:121] offset:1344
    s_add_u32 m0, s51, 65536
    s_nop 0
    buffer_load_dwordx4 v4, s[8:11], s55 offen lds
    s_add_u32 m0, s51, 69632
    s_nop 0
    buffer_load_dwordx4 v5, s[8:11], s55 offen lds
    s_add_u32 m0, s51, 73728
    s_nop 0
    buffer_load_dwordx4 v6, s[8:11], s55 offen lds
    s_waitcnt vmcnt(8)
    s_barrier
    s_add_u32 m0, s51, 114688
    s_nop 0
    buffer_load_dwordx4 v13, s[12:15], s64 offen lds
    s_add_u32 m0, s51, 118784
    s_nop 0
    buffer_load_dwordx4 v14, s[12:15], s64 offen lds
    s_add_u32 m0, s51, 122880
    s_nop 0
    buffer_load_dwordx4 v15, s[12:15], s64 offen lds
    s_add_u32 m0, s51, 126976
    s_nop 0
    buffer_load_dwordx4 v16, s[12:15], s64 offen lds
    s_add_u32 m0, s51, 98304
    s_nop 0
    buffer_load_dwordx4 v4, s[8:11], s56 offen lds
    s_add_u32 m0, s51, 102400
    s_nop 0
    buffer_load_dwordx4 v5, s[8:11], s56 offen lds
    s_add_u32 m0, s51, 106496
    s_nop 0
    buffer_load_dwordx4 v6, s[8:11], s56 offen lds
    s_waitcnt vmcnt(7)
    s_barrier
    s_or_b32 s70, s47, s4
    s_cmp_lg_u32 s70, 0
    s_cbranch_scc1 L_noack
    s_mov_b64 exec, 1
    global_store_dword v28, v30, s[42:43] sc0 sc1
    s_mov_b64 exec, -1
L_noack:
    s_add_u32 m0, s51, 147456
    s_nop 0
    buffer_load_dwordx4 v13, s[12:15], s65 offen lds
    s_add_u32 m0, s51, 151552
    s_nop 0
    buffer_load_dwordx4 v14, s[12:15], s65 offen lds
    s_add_u32 m0, s51, 155648
    s_nop 0
    buffer_load_dwordx4 v15, s[12:15], s65 offen lds
    ds_read2_b32 a[0:1], v44 offset0:0 offset1:1
    s_add_u32 m0, s51, 159744
    s_nop 0
    buffer_load_dwordx4 v16, s[12:15], s65 offen lds
    ds_read2_b32 a[2:3], v44 offset0:2 offset1:3
    s_add_u32 m0, s51, 131072
    s_nop 0
    buffer_load_dwordx4 v4, s[8:11], s57 offen lds
    ds_read2_b32 a[4:5], v45 offset0:0 offset1:1
    s_add_u32 m0, s51, 135168
    s_nop 0
    buffer_load_dwordx4 v5, s[8:11], s57 offen lds
    ds_read2_b32 a[6:7], v45 offset0:2 offset1:3
    s_add_u32 m0, s51, 139264
    s_nop 0
    buffer_load_dwordx4 v6, s[8:11], s57 offen lds
    ds_read2_b32 a[8:9], v46 offset0:0 offset1:1
    ds_read2_b32 a[10:11], v44 offset0:20 offset1:21
    ds_read2_b32 a[12:13], v44 offset0:22 offset1:23
    ds_read2_b32 a[14:15], v45 offset0:20 offset1:21
    s_waitcnt vmcnt(7)
    s_barrier
    s_add_u32 m0, s51, 49152
    s_nop 0
    buffer_load_dwordx4 v13, s[12:15], s66 offen lds
    s_add_u32 m0, s51, 53248
    s_nop 0
    buffer_load_dwordx4 v14, s[12:15], s66 offen lds
    s_add_u32 m0, s51, 57344
    s_nop 0
    buffer_load_dwordx4 v15, s[12:15], s66 offen lds
    ds_read2_b32 a[16:17], v45 offset0:22 offset1:23
    s_add_u32 m0, s51, 61440
    s_nop 0
    buffer_load_dwordx4 v16, s[12:15], s66 offen lds
    ds_read2_b32 a[18:19], v46 offset0:20 offset1:21
    s_add_u32 m0, s51, 32768
    s_nop 0
    buffer_load_dwordx4 v4, s[8:11], s58 offen lds
    ds_read2_b32 a[20:21], v44 offset0:40 offset1:41
    s_add_u32 m0, s51, 36864
    s_nop 0
    buffer_load_dwordx4 v5, s[8:11], s58 offen lds
    ds_read2_b32 a[22:23], v44 offset0:42 offset1:43
    s_add_u32 m0, s51, 40960
    s_nop 0
    buffer_load_dwordx4 v6, s[8:11], s58 offen lds
    ds_read2_b32 a[24:25], v45 offset0:40 offset1:41
    ds_read2_b32 a[26:27], v45 offset0:42 offset1:43
    ds_read2_b32 a[28:29], v46 offset0:40 offset1:41
    ds_read2_b32 a[30:31], v44 offset0:60 offset1:61
    s_waitcnt vmcnt(7)
    s_barrier
    s_add_u32 m0, s51, 81920
    s_nop 0
    buffer_load_dwordx4 v13, s[12:15], s67 offen lds
    s_add_u32 m0, s51, 86016
    s_nop 0
    buffer_load_dwordx4 v14, s[12:15], s67 offen lds
    s_add_u32 m0, s51, 90112
    s_nop 0
    buffer_load_dwordx4 v15, s[12:15], s67 offen lds
    ds_read2_b32 a[32:33], v44 offset0:62 offset1:63
    s_add_u32 m0, s51, 94208
    s_nop 0
    buffer_load_dwordx4 v16, s[12:15], s67 offen lds
    ds_read2_b32 a[34:35], v45 offset0:60 offset1:61
    s_add_u32 m0, s51, 65536
    s_nop 0
    buffer_load_dwordx4 v4, s[8:11], s59 offen lds
    ds_read2_b32 a[36:37], v45 offset0:62 offset1:63
    s_add_u32 m0, s51, 69632
    s_nop 0
    buffer_load_dwordx4 v5, s[8:11], s59 offen lds
    ds_read2_b32 a[38:39], v46 offset0:60 offset1:61
    s_add_u32 m0, s51, 73728
    s_nop 0
    buffer_load_dwordx4 v6, s[8:11], s59 offen lds
    ds_read2_b32 a[40:41], v44 offset0:80 offset1:81
    ds_read2_b32 a[42:43], v44 offset0:82 offset1:83
    ds_read2_b32 a[44:45], v45 offset0:80 offset1:81
    ds_read2_b32 a[46:47], v45 offset0:82 offset1:83
    s_waitcnt vmcnt(7)
    s_barrier
    s_add_u32 m0, s51, 114688
    s_nop 0
    buffer_load_dwordx4 v13, s[12:15], s68 offen lds
    s_add_u32 m0, s51, 118784
    s_nop 0
    buffer_load_dwordx4 v14, s[12:15], s68 offen lds
    s_add_u32 m0, s51, 122880
    s_nop 0
    buffer_load_dwordx4 v15, s[12:15], s68 offen lds
    ds_read2_b32 a[48:49], v46 offset0:80 offset1:81
    s_add_u32 m0, s51, 126976
    s_nop 0
    buffer_load_dwordx4 v16, s[12:15], s68 offen lds
    ds_read2_b32 a[50:51], v44 offset0:100 offset1:101
    s_add_u32 m0, s51, 98304
    s_nop 0
    buffer_load_dwordx4 v4, s[8:11], s60 offen lds
    ds_read2_b32 a[52:53], v44 offset0:102 offset1:103
    s_add_u32 m0, s51, 102400
    s_nop 0
    buffer_load_dwordx4 v5, s[8:11], s60 offen lds
    ds_read2_b32 a[54:55], v45 offset0:100 offset1:101
    s_add_u32 m0, s51, 106496
    s_nop 0
    buffer_load_dwordx4 v6, s[8:11], s60 offen lds
    ds_read2_b32 a[56:57], v45 offset0:102 offset1:103
    ds_read2_b32 a[58:59], v46 offset0:100 offset1:101
    ds_read2_b32 a[60:61], v44 offset0:120 offset1:121
    ds_read2_b32 a[62:63], v44 offset0:122 offset1:123
    s_waitcnt vmcnt(7)
    s_barrier
    s_add_u32 m0, s51, 147456
    s_nop 0
    buffer_load_dwordx4 v13, s[12:15], s69 offen lds
    s_add_u32 m0, s51, 151552
    s_nop 0
    buffer_load_dwordx4 v14, s[12:15], s69 offen lds
    s_add_u32 m0, s51, 155648
    s_nop 0
    buffer_load_dwordx4 v15, s[12:15], s69 offen lds
    ds_read2_b32 a[64:65], v45 offset0:120 offset1:121
    s_add_u32 m0, s51, 159744
    s_nop 0
    buffer_load_dwordx4 v16, s[12:15], s69 offen lds
    ds_read2_b32 a[66:67], v45 offset0:122 offset1:123
    s_add_u32 m0, s51, 131072
    s_nop 0
    buffer_load_dwordx4 v4, s[8:11], s61 offen lds
    ds_read2_b32 a[68:69], v46 offset0:120 offset1:121
    s_add_u32 m0, s51, 135168
    s_nop 0
    buffer_load_dwordx4 v5, s[8:11], s61 offen lds
    ds_read2_b32 a[70:71], v44 offset0:140 offset1:141
    s_add_u32 m0, s51, 139264
    s_nop 0
    buffer_load_dwordx4 v6, s[8:11], s61 offen lds
    ds_read2_b32 a[72:73], v44 offset0:142 offset1:143
    ds_read2_b32 a[74:75], v45 offset0:140 offset1:141
    ds_read2_b32 a[76:77], v45 offset0:142 offset1:143
    ds_read2_b32 a[78:79], v46 offset0:140 offset1:141
    s_waitcnt vmcnt(7)
    s_barrier
    s_add_u32 m0, s51, 32768
    s_nop 0
    buffer_load_dwordx4 v7, s[8:11], s54 offen lds
    s_add_u32 m0, s51, 36864
    s_nop 0
    buffer_load_dwordx4 v7, s[8:11], s55 offen lds
    s_add_u32 m0, s51, 40960
    s_nop 0
    buffer_load_dwordx4 v7, s[8:11], s56 offen lds
    s_add_u32 m0, s51, 45056
    s_nop 0
    buffer_load_dwordx4 v7, s[8:11], s57 offen lds
    s_add_u32 m0, s51, 49152
    s_nop 0
    buffer_load_dwordx4 v7, s[8:11], s58 offen lds
    s_add_u32 m0, s51, 53248
    s_nop 0
    buffer_load_dwordx4 v7, s[8:11], s59 offen lds
    s_add_u32 m0, s51, 57344
    s_nop 0
    buffer_load_dwordx4 v7, s[8:11], s60 offen lds
    s_add_u32 m0, s51, 61440
    s_nop 0
    buffer_load_dwordx4 v7, s[8:11], s61 offen lds
    global_load_dword v31, v28, s[42:43] sc1
    s_waitcnt lgkmcnt(0)
    s_waitcnt vmcnt(9)
    s_barrier
    s_add_u32 m0, s51, 65536
    s_nop 0
    buffer_load_dwordx4 v8, s[8:11], s54 offen lds
    s_add_u32 m0, s51, 69632
    s_nop 0
    buffer_load_dwordx4 v8, s[8:11], s55 offen lds
    s_add_u32 m0, s51, 73728
    s_nop 0
    buffer_load_dwordx4 v8, s[8:11], s56 offen lds
    s_add_u32 m0, s51, 77824
    s_nop 0
    buffer_load_dwordx4 v8, s[8:11], s57 offen lds
    s_add_u32 m0, s51, 81920
    s_nop 0
    buffer_load_dwordx4 v8, s[8:11], s58 offen lds
    s_add_u32 m0, s51, 86016
    s_nop 0
    buffer_load_dwordx4 v8, s[8:11], s59 offen lds
    s_add_u32 m0, s51, 90112
    s_nop 0
    buffer_load_dwordx4 v8, s[8:11], s60 offen lds
    s_add_u32 m0, s51, 94208
    s_nop 0
    buffer_load_dwordx4 v8, s[8:11], s61 offen lds
    s_mov_b32 exec_lo, 0xffff0000
    s_mov_b32 exec_hi, 0xffff
    buffer_load_dword v27, v25, s[8:11], 0 offen
    s_mov_b64 exec, -1
    s_waitcnt vmcnt(10)
    s_barrier
    s_add_u32 m0, s51, 98304
    s_nop 0
    buffer_load_dwordx4 v9, s[8:11], s54 offen lds
    s_add_u32 m0, s51, 102400
    s_nop 0
    buffer_load_dwordx4 v9, s[8:11], s55 offen lds
    s_add_u32 m0, s51, 106496
    s_nop 0
    buffer_load_dwordx4 v9, s[8:11], s56 offen lds
    s_add_u32 m0, s51, 110592
    s_nop 0
    buffer_load_dwordx4 v9, s[8:11], s57 offen lds
    s_add_u32 m0, s51, 114688
    s_nop 0
    buffer_load_dwordx4 v9, s[8:11], s58 offen lds
    s_add_u32 m0, s51, 118784
    s_nop 0
    buffer_load_dwordx4 v9, s[8:11], s59 offen lds
    s_add_u32 m0, s51, 122880
    s_nop 0
    buffer_load_dwordx4 v9, s[8:11], s60 offen lds
    s_add_u32 m0, s51, 126976
    s_nop 0
    buffer_load_dwordx4 v9, s[8:11], s61 offen lds
    s_waitcnt vmcnt(9)
    s_barrier
    s_add_u32 m0, s51, 131072
    s_nop 0
    buffer_load_dwordx4 v10, s[8:11], s54 offen lds
    s_add_u32 m0, s51, 135168
    s_nop 0
    buffer_load_dwordx4 v10, s[8:11], s55 offen lds
    s_add_u32 m0, s51, 139264
    s_nop 0
    buffer_load_dwordx4 v10, s[8:11], s56 offen lds
    s_add_u32 m0, s51, 143360
    s_nop 0
    buffer_load_dwordx4 v10, s[8:11], s57 offen lds
    s_add_u32 m0, s51, 147456
    s_nop 0
    buffer_load_dwordx4 v10, s[8:11], s58 offen lds
    s_add_u32 m0, s51, 151552
    s_nop 0
    buffer_load_dwordx4 v10, s[8:11], s59 offen lds
    s_add_u32 m0, s51, 155648
    s_nop 0
    buffer_load_dwordx4 v10, s[8:11], s60 offen lds
    s_add_u32 m0, s51, 159744
    s_nop 0
    buffer_load_dwordx4 v10, s[8:11], s61 offen lds
    s_add_u32 m0, s51, 32768
    s_nop 0
    buffer_load_dwordx4 v11, s[8:11], s54 offen lds
    s_add_u32 m0, s51, 36864
    s_nop 0
    buffer_load_dwordx4 v11, s[8:11], s55 offen lds
    s_add_u32 m0, s51, 40960
    s_nop 0
    buffer_load_dwordx4 v11, s[8:11], s56 offen lds
    s_add_u32 m0, s51, 45056
    s_nop 0
    buffer_load_dwordx4 v11, s[8:11], s57 offen lds
    s_add_u32 m0, s51, 49152
    s_nop 0
    buffer_load_dwordx4 v11, s[8:11], s58 offen lds
    s_add_u32 m0, s51, 53248
    s_nop 0
    buffer_load_dwordx4 v11, s[8:11], s59 offen lds
    s_add_u32 m0, s51, 57344
    s_nop 0
    buffer_load_dwordx4 v11, s[8:11], s60 offen lds
    s_add_u32 m0, s51, 61440
    s_nop 0
    buffer_load_dwordx4 v11, s[8:11], s61 offen lds
    v_cmp_ne_u32 vcc, 1, v31
    s_nop 1
    s_cmp_lg_u32 vcc_lo, 0
    s_cbranch_scc1 L_slow_ack
L_ok_ack:
    s_waitcnt vmcnt(16)
    s_barrier
    s_add_u32 m0, s51, 65536
    s_nop 0
    buffer_load_dwordx4 v12, s[8:11], s54 offen lds
    s_add_u32 m0, s51, 69632
    s_nop 0
    buffer_load_dwordx4 v12, s[8:11], s55 offen lds
    s_add_u32 m0, s51, 73728
    s_nop 0
    buffer_load_dwordx4 v12, s[8:11], s56 offen lds
    s_add_u32 m0, s51, 77824
    s_nop 0
    buffer_load_dwordx4 v12, s[8:11], s57 offen lds
    s_add_u32 m0, s51, 81920
    s_nop 0
    buffer_load_dwordx4 v12, s[8:11], s58 offen lds
    s_add_u32 m0, s51, 86016
    s_nop 0
    buffer_load_dwordx4 v12, s[8:11], s59 offen lds
    s_add_u32 m0, s51, 90112
    s_nop 0
    buffer_load_dwordx4 v12, s[8:11], s60 offen lds
    s_add_u32 m0, s51, 94208
    s_nop 0
    buffer_load_dwordx4 v12, s[8:11], s61 offen lds
    s_mov_b32 exec_lo, 0xffffffff
    s_mov_b32 exec_hi, 0
    buffer_load_dword v27, v26, s[24:27], 0 offen
    s_mov_b64 exec, -1
    s_barrier
    s_setprio 2
    ds_read_b64 a[88:89], v21 offset:0
    ds_read_b128 a[80:83], v19 offset:0
    ds_read_b128 a[84:87], v20 offset:0
    ds_read_b64 a[100:101], v21 offset:464
    ds_read_b128 a[92:95], v19 offset:464
    ds_read_b128 a[96:99], v20 offset:464
    ds_read_b64 a[112:113], v21 offset:928
    ds_read_b128 a[104:107], v19 offset:928
    ds_read_b128 a[108:111], v20 offset:928
    s_waitcnt lgkmcnt(8)
    v_mfma_f32_16x16x16_bf16 v[48:51], a[88:89], a[8:9], 0
    s_waitcnt lgkmcnt(5)
    v_mfma_f32_16x16x16_bf16 v[52:55], a[100:101], a[18:19], 0
    s_nop 3
    v_mfma_f32_16x16x32_bf16 v[48:51], a[80:83], a[0:3], v[48:51]
    v_mfma_f32_16x16x32_bf16 v[48:51], a[84:87], a[4:7], v[48:51]
    ds_read_b64 a[88:89], v21 offset:1392
    ds_read_b128 a[80:83], v19 offset:1392
    ds_read_b128 a[84:87], v20 offset:1392
    s_waitcnt lgkmcnt(5)
    v_mfma_f32_16x16x16_bf16 v[56:59], a[112:113], a[28:29], 0
    v_mfma_f32_16x16x32_bf16 v[52:55], a[92:95], a[10:13], v[52:55]
    v_mfma_f32_16x16x32_bf16 v[52:55], a[96:99], a[14:17], v[52:55]
    ds_read_b64 a[100:101], v21 offset:1856
    ds_read_b128 a[92:95], v19 offset:1856
    ds_read_b128 a[96:99], v20 offset:1856
    s_waitcnt lgkmcnt(5)
    v_mfma_f32_16x16x16_bf16 v[60:63], a[88:89], a[38:39], 0
    v_mfma_f32_16x16x32_bf16 v[56:59], a[104:107], a[20:23], v[56:59]
    v_mfma_f32_16x16x32_bf16 v[56:59], a[108:111], a[24:27], v[56:59]
    s_waitcnt vmcnt(17)
    s_barrier
    ds_read_b64 a[112:113], v21 offset:2320
    ds_read_b128 a[104:107], v19 offset:2320
    ds_read_b128 a[108:111], v20 offset:2320
    s_waitcnt lgkmcnt(5)
    v_mfma_f32_16x16x16_bf16 v[64:67], a[100:101], a[48:49], 0
    v_mfma_f32_16x16x32_bf16 v[60:63], a[80:83], a[30:33], v[60:63]
    v_mfma_f32_16x16x32_bf16 v[60:63], a[84:87], a[34:37], v[60:63]
    ds_read_b64 a[88:89], v21 offset:2784
    ds_read_b128 a[80:83], v19 offset:2784
    ds_read_b128 a[84:87], v20 offset:2784
    s_waitcnt lgkmcnt(5)
    v_mfma_f32_16x16x16_bf16 v[68:71], a[112:113], a[58:59], 0
    v_mfma_f32_16x16x32_bf16 v[64:67], a[92:95], a[40:43], v[64:67]
    v_mfma_f32_16x16x32_bf16 v[64:67], a[96:99], a[44:47], v[64:67]
    ds_read_b64 a[100:101], v21 offset:3248
    ds_read_b128 a[92:95], v19 offset:3248
    ds_read_b128 a[96:99], v20 offset:3248
    s_waitcnt lgkmcnt(5)
    v_mfma_f32_16x16x16_bf16 v[72:75], a[88:89], a[68:69], 0
    v_mfma_f32_16x16x32_bf16 v[68:71], a[104:107], a[50:53], v[68:71]
    v_mfma_f32_16x16x32_bf16 v[68:71], a[108:111], a[54:57], v[68:71]
    v_mul_f32 v80, s72, v48
    s_waitcnt lgkmcnt(2)
    v_mfma_f32_16x16x16_bf16 v[76:79], a[100:101], a[78:79], 0
    s_nop 0
    v_mfma_f32_16x16x32_bf16 v[72:75], a[80:83], a[60:63], v[72:75]
    v_mfma_f32_16x16x32_bf16 v[72:75], a[84:87], a[64:67], v[72:75]
    s_waitcnt lgkmcnt(1)
    s_nop 1
    v_mfma_f32_16x16x32_bf16 v[76:79], a[92:95], a[70:73], v[76:79]
    s_waitcnt lgkmcnt(0)
    v_mfma_f32_16x16x32_bf16 v[76:79], a[96:99], a[74:77], v[76:79]
    v_mul_f32 v81, s72, v49
    v_mul_f32 v82, s72, v52
    v_mul_f32 v83, s72, v53
    v_exp_f32 v80, v80
    v_exp_f32 v81, v81
    v_exp_f32 v82, v82
    v_exp_f32 v83, v83
    v_add_f32 v80, 1.0, v80
    v_add_f32 v81, 1.0, v81
    v_add_f32 v82, 1.0, v82
    v_add_f32 v83, 1.0, v83
    v_rcp_f32 v80, v80
    v_rcp_f32 v81, v81
    v_rcp_f32 v82, v82
    v_rcp_f32 v83, v83
    v_mul_f32 v48, v48, v80
    v_mul_f32 v49, v49, v81
    v_mul_f32 v52, v52, v82
    v_mul_f32 v53, v53, v83
    v_cvt_pk_bf16_f32 v88, v48, v52
    v_cvt_pk_bf16_f32 v92, v49, v53
    v_mul_f32 v84, s72, v56
    v_mul_f32 v85, s72, v57
    v_mul_f32 v86, s72, v60
    v_mul_f32 v87, s72, v61
    v_exp_f32 v84, v84
    v_exp_f32 v85, v85
    v_exp_f32 v86, v86
    v_exp_f32 v87, v87
    v_add_f32 v84, 1.0, v84
    v_add_f32 v85, 1.0, v85
    v_add_f32 v86, 1.0, v86
    v_add_f32 v87, 1.0, v87
    v_rcp_f32 v84, v84
    v_rcp_f32 v85, v85
    v_rcp_f32 v86, v86
    v_rcp_f32 v87, v87
    v_mul_f32 v56, v56, v84
    v_mul_f32 v57, v57, v85
    v_mul_f32 v60, v60, v86
    v_mul_f32 v61, v61, v87
    v_cvt_pk_bf16_f32 v89, v56, v60
    v_cvt_pk_bf16_f32 v93, v57, v61
    v_mul_f32 v80, s72, v64
    v_mul_f32 v81, s72, v65
    v_mul_f32 v82, s72, v68
    v_mul_f32 v83, s72, v69
    v_exp_f32 v80, v80
    v_exp_f32 v81, v81
    v_exp_f32 v82, v82
    v_exp_f32 v83, v83
    v_add_f32 v80, 1.0, v80
    v_add_f32 v81, 1.0, v81
    v_add_f32 v82, 1.0, v82
    v_add_f32 v83, 1.0, v83
    v_rcp_f32 v80, v80
    v_rcp_f32 v81, v81
    v_rcp_f32 v82, v82
    v_rcp_f32 v83, v83
    v_mul_f32 v64, v64, v80
    v_mul_f32 v65, v65, v81
    v_mul_f32 v68, v68, v82
    v_mul_f32 v69, v69, v83
    v_cvt_pk_bf16_f32 v90, v64, v68
    v_cvt_pk_bf16_f32 v94, v65, v69
    v_mul_f32 v84, s72, v72
    v_mul_f32 v85, s72, v73
    v_mul_f32 v86, s72, v76
    v_mul_f32 v87, s72, v77
    v_exp_f32 v84, v84
    v_exp_f32 v85, v85
    v_exp_f32 v86, v86
    v_exp_f32 v87, v87
    v_add_f32 v84, 1.0, v84
    v_add_f32 v85, 1.0, v85
    v_add_f32 v86, 1.0, v86
    v_add_f32 v87, 1.0, v87
    v_rcp_f32 v84, v84
    v_rcp_f32 v85, v85
    v_rcp_f32 v86, v86
    v_rcp_f32 v87, v87
    v_mul_f32 v72, v72, v84
    v_mul_f32 v73, v73, v85
    v_mul_f32 v76, v76, v86
    v_mul_f32 v77, v77, v87
    v_cvt_pk_bf16_f32 v91, v72, v76
    v_cvt_pk_bf16_f32 v95, v73, v77
    buffer_store_dwordx4 v[88:91], v18, s[20:23], 0 offen sc0 sc1
    buffer_store_dwordx4 v[92:95], v18, s[20:23], 0 offen offset:512 sc0 sc1
    v_mul_f32 v80, s72, v50
    s_waitcnt vmcnt(11)
    s_barrier
    v_mul_f32 v81, s72, v51
    v_mul_f32 v82, s72, v54
    v_mul_f32 v83, s72, v55
    v_exp_f32 v80, v80
    v_exp_f32 v81, v81
    v_exp_f32 v82, v82
    v_exp_f32 v83, v83
    v_add_f32 v80, 1.0, v80
    v_add_f32 v81, 1.0, v81
    v_add_f32 v82, 1.0, v82
    v_add_f32 v83, 1.0, v83
    v_rcp_f32 v80, v80
    v_rcp_f32 v81, v81
    v_rcp_f32 v82, v82
    v_rcp_f32 v83, v83
    v_mul_f32 v50, v50, v80
    v_mul_f32 v51, v51, v81
    v_mul_f32 v54, v54, v82
    v_mul_f32 v55, v55, v83
    v_cvt_pk_bf16_f32 v96, v50, v54
    v_cvt_pk_bf16_f32 v100, v51, v55
    v_mul_f32 v84, s72, v58
    v_mul_f32 v85, s72, v59
    v_mul_f32 v86, s72, v62
    v_mul_f32 v87, s72, v63
    v_exp_f32 v84, v84
    v_exp_f32 v85, v85
    v_exp_f32 v86, v86
    v_exp_f32 v87, v87
    v_add_f32 v84, 1.0, v84
    v_add_f32 v85, 1.0, v85
    v_add_f32 v86, 1.0, v86
    v_add_f32 v87, 1.0, v87
    v_rcp_f32 v84, v84
    v_rcp_f32 v85, v85
    v_rcp_f32 v86, v86
    v_rcp_f32 v87, v87
    v_mul_f32 v58, v58, v84
    v_mul_f32 v59, v59, v85
    v_mul_f32 v62, v62, v86
    v_mul_f32 v63, v63, v87
    v_cvt_pk_bf16_f32 v97, v58, v62
    v_cvt_pk_bf16_f32 v101, v59, v63
    v_mul_f32 v80, s72, v66
    v_mul_f32 v81, s72, v67
    v_mul_f32 v82, s72, v70
    v_mul_f32 v83, s72, v71
    v_exp_f32 v80, v80
    v_exp_f32 v81, v81
    v_exp_f32 v82, v82
    v_exp_f32 v83, v83
    v_add_f32 v80, 1.0, v80
    v_add_f32 v81, 1.0, v81
    v_add_f32 v82, 1.0, v82
    v_add_f32 v83, 1.0, v83
    v_rcp_f32 v80, v80
    v_rcp_f32 v81, v81
    v_rcp_f32 v82, v82
    v_rcp_f32 v83, v83
    v_mul_f32 v66, v66, v80
    v_mul_f32 v67, v67, v81
    v_mul_f32 v70, v70, v82
    v_mul_f32 v71, v71, v83
    v_cvt_pk_bf16_f32 v98, v66, v70
    v_cvt_pk_bf16_f32 v102, v67, v71
    v_mul_f32 v84, s72, v74
    v_mul_f32 v85, s72, v75
    v_mul_f32 v86, s72, v78
    v_mul_f32 v87, s72, v79
    v_exp_f32 v84, v84
    v_exp_f32 v85, v85
    v_exp_f32 v86, v86
    v_exp_f32 v87, v87
    v_add_f32 v84, 1.0, v84
    v_add_f32 v85, 1.0, v85
    v_add_f32 v86, 1.0, v86
    v_add_f32 v87, 1.0, v87
    v_rcp_f32 v84, v84
    v_rcp_f32 v85, v85
    v_rcp_f32 v86, v86
    v_rcp_f32 v87, v87
    v_mul_f32 v74, v74, v84
    v_mul_f32 v75, v75, v85
    v_mul_f32 v78, v78, v86
    v_mul_f32 v79, v79, v87
    v_cvt_pk_bf16_f32 v99, v74, v78
    v_cvt_pk_bf16_f32 v103, v75, v79
    buffer_store_dwordx4 v[96:99], v18, s[20:23], 0 offen offset:1024 sc0 sc1
    buffer_store_dwordx4 v[100:103], v18, s[20:23], 0 offen offset:1536 sc0 sc1
    s_waitcnt vmcnt(5)
    s_barrier
    s_waitcnt vmcnt(0)
    s_mov_b32 exec_lo, s49
    s_mov_b32 exec_hi, 0
    buffer_store_dword v30, v29, s[20:23], 0 offen sc0 sc1
    s_mov_b64 exec, -1
    s_barrier
    s_setprio 2
    s_mov_b32 exec_lo, -1
    s_mov_b32 exec_hi, 0
    buffer_load_dword v125, v29, s[20:23], 0 offen sc1
    s_mov_b64 exec, -1
    ds_read_b64 a[88:89], v24 offset:0
    ds_read_b128 a[80:83], v22 offset:0
    ds_read_b128 a[84:87], v23 offset:0
    ds_read_b64 a[100:101], v24 offset:464
    ds_read_b128 a[92:95], v22 offset:464
    ds_read_b128 a[96:99], v23 offset:464
    ds_read_b64 a[112:113], v24 offset:928
    ds_read_b128 a[104:107], v22 offset:928
    ds_read_b128 a[108:111], v23 offset:928
    s_waitcnt lgkmcnt(8)
    v_mfma_f32_16x16x16_bf16 v[48:51], a[88:89], a[8:9], 0
    s_waitcnt lgkmcnt(5)
    v_mfma_f32_16x16x16_bf16 v[52:55], a[100:101], a[18:19], 0
    s_nop 3
    v_mfma_f32_16x16x32_bf16 v[48:51], a[80:83], a[0:3], v[48:51]
    v_mfma_f32_16x16x32_bf16 v[48:51], a[84:87], a[4:7], v[48:51]
    ds_read_b64 a[88:89], v24 offset:1392
    ds_read_b128 a[80:83], v22 offset:1392
    ds_read_b128 a[84:87], v23 offset:1392
    s_waitcnt lgkmcnt(5)
    v_mfma_f32_16x16x16_bf16 v[56:59], a[112:113], a[28:29], 0
    v_mfma_f32_16x16x32_bf16 v[52:55], a[92:95], a[10:13], v[52:55]
    v_mfma_f32_16x16x32_bf16 v[52:55], a[96:99], a[14:17], v[52:55]
    ds_read_b64 a[100:101], v24 offset:1856
    ds_read_b128 a[92:95], v22 offset:1856
    ds_read_b128 a[96:99], v23 offset:1856
    v_pk_mul_f32 v[80:81], v[48:49], s[72:73]
    s_nop 3
    v_pk_mul_f32 v[82:83], v[52:53], s[72:73]
    v_exp_f32 v80, v80
    v_exp_f32 v81, v81
    s_waitcnt lgkmcnt(5)
    v_mfma_f32_16x16x16_bf16 v[60:63], a[88:89], a[38:39], 0
    v_mfma_f32_16x16x32_bf16 v[56:59], a[104:107], a[20:23], v[56:59]
    v_mfma_f32_16x16x32_bf16 v[56:59], a[108:111], a[24:27], v[56:59]
    ds_read_b64 a[112:113], v24 offset:2320
    ds_read_b128 a[104:107], v22 offset:2320
    ds_read_b128 a[108:111], v23 offset:2320
    s_waitcnt lgkmcnt(5)
    v_mfma_f32_16x16x16_bf16 v[64:67], a[100:101], a[48:49], 0
    v_mfma_f32_16x16x32_bf16 v[60:63], a[80:83], a[30:33], v[60:63]
    v_mfma_f32_16x16x32_bf16 v[60:63], a[84:87], a[34:37], v[60:63]
    ds_read_b64 a[88:89], v24 offset:2784
    ds_read_b128 a[80:83], v22 offset:2784
    ds_read_b128 a[84:87], v23 offset:2784
    v_exp_f32 v82, v82
    s_waitcnt lgkmcnt(5)
    v_mfma_f32_16x16x16_bf16 v[68:71], a[112:113], a[58:59], 0
    v_mfma_f32_16x16x32_bf16 v[64:67], a[92:95], a[40:43], v[64:67]
    v_mfma_f32_16x16x32_bf16 v[64:67], a[96:99], a[44:47], v[64:67]
    ds_read_b64 a[100:101], v24 offset:3248
    ds_read_b128 a[92:95], v22 offset:3248
    ds_read_b128 a[96:99], v23 offset:3248
    v_exp_f32 v83, v83
    s_waitcnt lgkmcnt(5)
    v_mfma_f32_16x16x16_bf16 v[72:75], a[88:89], a[68:69], 0
    v_mfma_f32_16x16x32_bf16 v[68:71], a[104:107], a[50:53], v[68:71]
    v_mfma_f32_16x16x32_bf16 v[68:71], a[108:111], a[54:57], v[68:71]
    v_pk_add_f32 v[80:81], v[80:81], 1.0 op_sel_hi:[1,0]
    v_pk_add_f32 v[82:83], v[82:83], 1.0 op_sel_hi:[1,0]
    s_waitcnt lgkmcnt(2)
    v_mfma_f32_16x16x16_bf16 v[76:79], a[100:101], a[78:79], 0
    v_mfma_f32_16x16x32_bf16 v[72:75], a[80:83], a[60:63], v[72:75]
    v_mfma_f32_16x16x32_bf16 v[72:75], a[84:87], a[64:67], v[72:75]
    s_waitcnt lgkmcnt(1)
    s_nop 2
    v_mfma_f32_16x16x32_bf16 v[76:79], a[92:95], a[70:73], v[76:79]
    s_waitcnt lgkmcnt(0)
    v_mfma_f32_16x16x32_bf16 v[76:79], a[96:99], a[74:77], v[76:79]
    v_rcp_f32 v80, v80
    v_rcp_f32 v81, v81
    v_rcp_f32 v82, v82
    v_rcp_f32 v83, v83
    v_pk_mul_f32 v[48:49], v[48:49], v[80:81]
    v_pk_mul_f32 v[52:53], v[52:53], v[82:83]
    v_cvt_pk_bf16_f32 v88, v48, v52
    v_cvt_pk_bf16_f32 v92, v49, v53
    v_pk_mul_f32 v[84:85], v[56:57], s[72:73]
    v_pk_mul_f32 v[86:87], v[60:61], s[72:73]
    v_exp_f32 v84, v84
    v_exp_f32 v85, v85
    v_exp_f32 v86, v86
    v_exp_f32 v87, v87
    v_pk_add_f32 v[84:85], v[84:85], 1.0 op_sel_hi:[1,0]
    v_pk_add_f32 v[86:87], v[86:87], 1.0 op_sel_hi:[1,0]
    v_rcp_f32 v84, v84
    v_rcp_f32 v85, v85
    v_rcp_f32 v86, v86
    v_rcp_f32 v87, v87
    v_pk_mul_f32 v[56:57], v[56:57], v[84:85]
    v_pk_mul_f32 v[60:61], v[60:61], v[86:87]
    s_waitcnt vmcnt(0)
    v_cmp_ne_u32 vcc, 1, v125
    s_nop 1
    s_cmp_lg_u32 vcc_lo, 0
    s_cbranch_scc1 L_noearly
    s_mov_b32 exec_hi, 0
    buffer_load_dword v27, v17, s[20:23], s36 offen sc1
    s_mov_b64 exec, -1
L_noearly:
    v_cvt_pk_bf16_f32 v89, v56, v60
    v_cvt_pk_bf16_f32 v93, v57, v61
    v_pk_mul_f32 v[80:81], v[64:65], s[72:73]
    v_pk_mul_f32 v[82:83], v[68:69], s[72:73]
    v_exp_f32 v80, v80
    v_exp_f32 v81, v81
    v_exp_f32 v82, v82
    v_exp_f32 v83, v83
    v_pk_add_f32 v[80:81], v[80:81], 1.0 op_sel_hi:[1,0]
    v_pk_add_f32 v[82:83], v[82:83], 1.0 op_sel_hi:[1,0]
    v_rcp_f32 v80, v80
    v_rcp_f32 v81, v81
    v_rcp_f32 v82, v82
    v_rcp_f32 v83, v83
    v_pk_mul_f32 v[64:65], v[64:65], v[80:81]
    v_pk_mul_f32 v[68:69], v[68:69], v[82:83]
    v_cvt_pk_bf16_f32 v90, v64, v68
    v_cvt_pk_bf16_f32 v94, v65, v69
    v_pk_mul_f32 v[84:85], v[72:73], s[72:73]
    v_pk_mul_f32 v[86:87], v[76:77], s[72:73]
    v_exp_f32 v84, v84
    v_exp_f32 v85, v85
    v_exp_f32 v86, v86
    v_exp_f32 v87, v87
    v_pk_add_f32 v[84:85], v[84:85], 1.0 op_sel_hi:[1,0]
    v_pk_add_f32 v[86:87], v[86:87], 1.0 op_sel_hi:[1,0]
    v_rcp_f32 v84, v84
    v_rcp_f32 v85, v85
    v_rcp_f32 v86, v86
    v_rcp_f32 v87, v87
    v_pk_mul_f32 v[72:73], v[72:73], v[84:85]
    v_pk_mul_f32 v[76:77], v[76:77], v[86:87]
    v_cvt_pk_bf16_f32 v91, v72, v76
    v_cvt_pk_bf16_f32 v95, v73, v77
    buffer_store_dwordx4 v[88:91], v18, s[20:23], 0 offen offset:2048 sc0 sc1
    buffer_store_dwordx4 v[92:95], v18, s[20:23], 0 offen offset:2560 sc0 sc1
    v_pk_mul_f32 v[80:81], v[50:51], s[72:73]
    v_pk_mul_f32 v[82:83], v[54:55], s[72:73]
    v_exp_f32 v80, v80
    v_exp_f32 v81, v81
    v_exp_f32 v82, v82
    v_exp_f32 v83, v83
    v_pk_add_f32 v[80:81], v[80:81], 1.0 op_sel_hi:[1,0]
    v_pk_add_f32 v[82:83], v[82:83], 1.0 op_sel_hi:[1,0]
    v_rcp_f32 v80, v80
    v_rcp_f32 v81, v81
    v_rcp_f32 v82, v82
    v_rcp_f32 v83, v83
    v_pk_mul_f32 v[50:51], v[50:51], v[80:81]
    v_pk_mul_f32 v[54:55], v[54:55], v[82:83]
    v_cvt_pk_bf16_f32 v96, v50, v54
    v_cvt_pk_bf16_f32 v100, v51, v55
    v_pk_mul_f32 v[84:85], v[58:59], s[72:73]
    v_pk_mul_f32 v[86:87], v[62:63], s[72:73]
    v_exp_f32 v84, v84
    v_exp_f32 v85, v85
    v_exp_f32 v86, v86
    v_exp_f32 v87, v87
    v_pk_add_f32 v[84:85], v[84:85], 1.0 op_sel_hi:[1,0]
    v_pk_add_f32 v[86:87], v[86:87], 1.0 op_sel_hi:[1,0]
    v_rcp_f32 v84, v84
    v_rcp_f32 v85, v85
    v_rcp_f32 v86, v86
    v_rcp_f32 v87, v87
    v_pk_mul_f32 v[58:59], v[58:59], v[84:85]
    v_pk_mul_f32 v[62:63], v[62:63], v[86:87]
    v_cvt_pk_bf16_f32 v97, v58, v62
    v_cvt_pk_bf16_f32 v101, v59, v63
    v_pk_mul_f32 v[80:81], v[66:67], s[72:73]
    v_pk_mul_f32 v[82:83], v[70:71], s[72:73]
    v_exp_f32 v80, v80
    v_exp_f32 v81, v81
    v_exp_f32 v82, v82
    v_exp_f32 v83, v83
    v_pk_add_f32 v[80:81], v[80:81], 1.0 op_sel_hi:[1,0]
    v_pk_add_f32 v[82:83], v[82:83], 1.0 op_sel_hi:[1,0]
    v_rcp_f32 v80, v80
    v_rcp_f32 v81, v81
    v_rcp_f32 v82, v82
    v_rcp_f32 v83, v83
    v_pk_mul_f32 v[66:67], v[66:67], v[80:81]
    v_pk_mul_f32 v[70:71], v[70:71], v[82:83]
    v_cvt_pk_bf16_f32 v98, v66, v70
    v_cvt_pk_bf16_f32 v102, v67, v71
    v_pk_mul_f32 v[84:85], v[74:75], s[72:73]
    v_pk_mul_f32 v[86:87], v[78:79], s[72:73]
    v_exp_f32 v84, v84
    v_exp_f32 v85, v85
    v_exp_f32 v86, v86
    v_exp_f32 v87, v87
    v_pk_add_f32 v[84:85], v[84:85], 1.0 op_sel_hi:[1,0]
    v_pk_add_f32 v[86:87], v[86:87], 1.0 op_sel_hi:[1,0]
    v_rcp_f32 v84, v84
    v_rcp_f32 v85, v85
    v_rcp_f32 v86, v86
    v_rcp_f32 v87, v87
    v_pk_mul_f32 v[74:75], v[74:75], v[84:85]
    v_pk_mul_f32 v[78:79], v[78:79], v[86:87]
    v_cvt_pk_bf16_f32 v99, v74, v78
    v_cvt_pk_bf16_f32 v103, v75, v79
    buffer_store_dwordx4 v[96:99], v18, s[20:23], 0 offen offset:3072 sc0 sc1
    buffer_store_dwordx4 v[100:103], v18, s[20:23], 0 offen offset:3584 sc0 sc1
    s_barrier
    v_cmp_ne_u32 vcc, 1, v125
    s_nop 1
    s_cmp_lg_u32 vcc_lo, 0
    s_cbranch_scc1 L_slow_p0
L_ok_p0:
    s_add_u32 m0, s51, 98304
    s_add_u32 s70, s36, 0
    buffer_load_dwordx4 v124, s[20:23], s70 offen sc1 lds
    s_add_u32 m0, s51, 102400
    s_add_u32 s70, s36, 524288
    buffer_load_dwordx4 v124, s[20:23], s70 offen sc1 lds
    s_add_u32 m0, s51, 106496
    s_add_u32 s70, s36, 1048576
    buffer_load_dwordx4 v124, s[20:23], s70 offen sc1 lds
    s_add_u32 m0, s51, 110592
    s_add_u32 s70, s36, 1572864
    buffer_load_dwordx4 v124, s[20:23], s70 offen sc1 lds
    s_add_u32 m0, s51, 114688
    s_add_u32 s70, s37, 0
    buffer_load_dwordx4 v124, s[20:23], s70 offen sc1 lds
    s_add_u32 m0, s51, 118784
    s_add_u32 s70, s37, 524288
    buffer_load_dwordx4 v124, s[20:23], s70 offen sc1 lds
    s_add_u32 m0, s51, 122880
    s_add_u32 s70, s37, 1048576
    buffer_load_dwordx4 v124, s[20:23], s70 offen sc1 lds
    s_add_u32 m0, s51, 126976
    s_add_u32 s70, s37, 1572864
    buffer_load_dwordx4 v124, s[20:23], s70 offen sc1 lds
    s_waitcnt vmcnt(8)
    s_mov_b32 exec_lo, 0
    s_mov_b32 exec_hi, s49
    buffer_store_dword v30, v29, s[20:23], 0 offen sc0 sc1
    s_mov_b64 exec, -1
    s_waitcnt vmcnt(5)
    s_barrier
    s_add_u32 m0, s51, 131072
    s_add_u32 s70, s38, 0
    buffer_load_dwordx4 v124, s[20:23], s70 offen sc1 lds
    s_add_u32 m0, s51, 135168
    s_add_u32 s70, s38, 524288
    buffer_load_dwordx4 v124, s[20:23], s70 offen sc1 lds
    s_add_u32 m0, s51, 139264
    s_add_u32 s70, s38, 1048576
    buffer_load_dwordx4 v124, s[20:23], s70 offen sc1 lds
    s_add_u32 m0, s51, 143360
    s_add_u32 s70, s38, 1572864
    buffer_load_dwordx4 v124, s[20:23], s70 offen sc1 lds
    s_add_u32 m0, s51, 147456
    s_add_u32 s70, s39, 0
    buffer_load_dwordx4 v124, s[20:23], s70 offen sc1 lds
    s_add_u32 m0, s51, 151552
    s_add_u32 s70, s39, 524288
    buffer_load_dwordx4 v124, s[20:23], s70 offen sc1 lds
    s_add_u32 m0, s51, 155648
    s_add_u32 s70, s39, 1048576
    buffer_load_dwordx4 v124, s[20:23], s70 offen sc1 lds
    s_add_u32 m0, s51, 159744
    s_add_u32 s70, s39, 1572864
    buffer_load_dwordx4 v124, s[20:23], s70 offen sc1 lds
    s_waitcnt vmcnt(9)
    s_barrier
    s_waitcnt vmcnt(4)
    s_barrier
    s_mov_b32 exec_lo, 0
    s_mov_b32 exec_hi, -1
    buffer_load_dword v125, v29, s[20:23], 0 offen sc1
    s_mov_b64 exec, -1
    s_waitcnt vmcnt(1)
    s_barrier
    s_waitcnt vmcnt(0)
    v_cmp_ne_u32 vcc, 1, v125
    s_nop 1
    s_cmp_lg_u32 vcc_hi, 0
    s_cbranch_scc1 L_slow_p1
L_ok_p1:
    s_add_u32 m0, s51, 32768
    s_add_u32 s70, s36, 2048
    buffer_load_dwordx4 v124, s[20:23], s70 offen sc1 lds
    s_add_u32 m0, s51, 36864
    s_add_u32 s70, s36, 526336
    buffer_load_dwordx4 v124, s[20:23], s70 offen sc1 lds
    s_add_u32 m0, s51, 40960
    s_add_u32 s70, s36, 1050624
    buffer_load_dwordx4 v124, s[20:23], s70 offen sc1 lds
    s_add_u32 m0, s51, 45056
    s_add_u32 s70, s36, 1574912
    buffer_load_dwordx4 v124, s[20:23], s70 offen sc1 lds
    s_add_u32 m0, s51, 49152
    s_add_u32 s70, s37, 2048
    buffer_load_dwordx4 v124, s[20:23], s70 offen sc1 lds
    s_add_u32 m0, s51, 53248
    s_add_u32 s70, s37, 526336
    buffer_load_dwordx4 v124, s[20:23], s70 offen sc1 lds
    s_add_u32 m0, s51, 57344
    s_add_u32 s70, s37, 1050624
    buffer_load_dwordx4 v124, s[20:23], s70 offen sc1 lds
    s_add_u32 m0, s51, 61440
    s_add_u32 s70, s37, 1574912
    buffer_load_dwordx4 v124, s[20:23], s70 offen sc1 lds
    s_waitcnt vmcnt(4)
    s_barrier
    s_add_u32 m0, s51, 65536
    s_add_u32 s70, s38, 2048
    buffer_load_dwordx4 v124, s[20:23], s70 offen sc1 lds
    s_add_u32 m0, s51, 69632
    s_add_u32 s70, s38, 526336
    buffer_load_dwordx4 v124, s[20:23], s70 offen sc1 lds
    s_add_u32 m0, s51, 73728
    s_add_u32 s70, s38, 1050624
    buffer_load_dwordx4 v124, s[20:23], s70 offen sc1 lds
    s_add_u32 m0, s51, 77824
    s_add_u32 s70, s38, 1574912
    buffer_load_dwordx4 v124, s[20:23], s70 offen sc1 lds
    s_add_u32 m0, s51, 81920
    s_add_u32 s70, s39, 2048
    buffer_load_dwordx4 v124, s[20:23], s70 offen sc1 lds
    s_add_u32 m0, s51, 86016
    s_add_u32 s70, s39, 526336
    buffer_load_dwordx4 v124, s[20:23], s70 offen sc1 lds
    s_add_u32 m0, s51, 90112
    s_add_u32 s70, s39, 1050624
    buffer_load_dwordx4 v124, s[20:23], s70 offen sc1 lds
    s_add_u32 m0, s51, 94208
    s_add_u32 s70, s39, 1574912
    buffer_load_dwordx4 v124, s[20:23], s70 offen sc1 lds
    s_waitcnt vmcnt(8)
    s_barrier
    s_waitcnt vmcnt(4)
    s_barrier
    s_waitcnt vmcnt(0)
    s_barrier
    s_barrier
    ds_read_b128 v[48:51], v126 offset:0
    v_xor_b32 v126, 64, v126
    ds_read_b128 v[52:55], v126 offset:1024
    v_xor_b32 v126, 64, v126
    s_mov_b32 s70, 0
    s_waitcnt lgkmcnt(1)
    buffer_store_dwordx4 v[48:51], v127, s[28:31], s70 offen sc1
    s_mov_b32 s70, 4096
    s_waitcnt lgkmcnt(0)
    buffer_store_dwordx4 v[52:55], v127, s[28:31], s70 offen sc1
    ds_read_b128 v[56:59], v126 offset:8192
    v_xor_b32 v126, 64, v126
    ds_read_b128 v[60:63], v126 offset:9216
    v_xor_b32 v126, 64, v126
    s_mov_b32 s70, 32768
    s_waitcnt lgkmcnt(1)
    buffer_store_dwordx4 v[56:59], v127, s[28:31], s70 offen sc1
    s_mov_b32 s70, 36864
    s_waitcnt lgkmcnt(0)
    buffer_store_dwordx4 v[60:63], v127, s[28:31], s70 offen sc1
    s_barrier
    ds_read_b128 v[64:67], v126 offset:24576
    v_xor_b32 v126, 64, v126
    ds_read_b128 v[68:71], v126 offset:25600
    v_xor_b32 v126, 64, v126
    s_mov_b32 s70, 163840
    s_waitcnt lgkmcnt(1)
    buffer_store_dwordx4 v[64:67], v127, s[28:31], s70 offen sc1
    s_mov_b32 s70, 167936
    s_waitcnt lgkmcnt(0)
    buffer_store_dwordx4 v[68:71], v127, s[28:31], s70 offen sc1
L_end:
    s_endpgm
L_C:
    s_setprio 1
    v_mov_b32 v48, v1
    v_mov_b32 v49, v2
    v_mov_b32 v50, v3
    v_mov_b32 v0, v1
    s_getpc_b64 s[6:7]
L_pc:
    s_sub_u32 s6, s6, (L_pc-standalone__conformer_conv_module__speech_kernel)
    s_subb_u32 s7, s7, 0
    v_lshrrev_b32 v51, 5, v48
    s_lshl_b32 s5, s4, 1
    v_add_u32 v51, s5, v51
    v_lshlrev_b32 v51, 7, v51
    s_lshl_b32 s5, s71, 10
    v_add_u32 v51, s5, v51
    v_min_u32 v51, (L_code_end-standalone__conformer_conv_module__speech_kernel-4), v51
    global_load_dword v58, v51, s[6:7]
    v_mov_b32 v54, 0x80000000
    v_lshrrev_b32 v51, 2, v49
    v_and_b32 v52, 3, v49
    v_lshl_add_u32 v53, v51, 3, v52
    v_lshrrev_b32 v52, 1, v52
    v_lshl_add_u32 v52, v51, 1, v52
    v_xor_b32 v52, v52, v50
    v_lshlrev_b32 v52, 4, v52
    v_lshl_add_u32 v52, v53, 7, v52
    v_add_u32 v1, 32768, v52
    v_xor_b32 v2, 64, v1
    v_and_b32 v52, 1, v50
    v_lshlrev_b32 v52, 2, v52
    v_or_b32 v52, v52, v51
    v_lshl_add_u32 v53, v50, 3, v51
    v_lshlrev_b32 v53, 8, v53
    v_and_b32 v55, 3, v49
    v_lshl_add_u32 v53, v55, 3, v53
    v_xor_b32 v56, s4, v52
    v_lshl_add_u32 v56, v56, 5, v53
    v_add_u32 v5, 32768, v56
    v_xor_b32 v3, 128, v5
    s_lshl_b32 s5, s4, 1
    v_xor_b32 v56, s5, v52
    v_lshl_add_u32 v56, v56, 5, v53
    v_add_u32 v9, 32768, v56
    v_add_u32 v10, 98304, v56
    s_mul_i32 s3, s4, 7424
    v_mul_u32_u24 v51, 464, v49
    v_lshl_add_u32 v51, v50, 4, v51
    v_add_u32 v6, s3, v51
    v_lshlrev_b32 v51, 10, v50
    v_lshl_add_u32 v51, v49, 4, v51
    v_add_u32 v7, 32768, v51
    v_add_u32 v8, 98304, v51
    v_and_b32 v52, 1, v50
    v_lshlrev_b32 v52, 1, v52
    v_lshrrev_b32 v53, 1, v50
    v_or_b32 v52, v52, v53
    s_lshl_b32 s5, s4, 2
    v_or_b32 v52, s5, v52
    v_and_b32 v53, 7, v49
    v_xor_b32 v52, v52, v53
    v_lshlrev_b32 v52, 4, v52
    v_lshl_add_u32 v11, v49, 8, v52
    s_lshl_b32 s5, s4, 3
    v_add_u32 v51, s5, v50
    v_xor_b32 v52, v49, v50
    v_lshlrev_b32 v52, 4, v52
    v_lshl_add_u32 v13, v51, 8, v52
    s_lshr_b32 s5, s47, 2
    s_lshl_b32 s5, s5, 6
    v_add_u32 v51, s5, v51
    s_mul_i32 s5, s48, 4000
    s_add_u32 s5, s5, s50
    s_add_u32 s5, s5, 16
    v_add_u32 v51, s5, v51
    s_and_b32 s6, s47, 3
    s_lshl_b32 s6, s6, 8
    v_lshlrev_b32 v52, 4, v49
    v_add_u32 v52, s6, v52
    v_lshl_add_u32 v14, v51, 10, v52
    s_add_u32 s5, s5, 250
    s_lshl_b32 s52, s5, 10
    s_mov_b32 s72, 0xbfb8aa3b
    s_mov_b32 s73, 0xbfb8aa3b
    s_waitcnt lgkmcnt(0)
    s_mov_b32 s28, s40
    s_and_b32 s29, s41, 0xffff
    s_mov_b32 s30, s52
    s_mov_b32 s31, 0x20000
    s_mov_b32 s24, s38
    s_and_b32 s25, s39, 0xffff
    s_mov_b32 s26, 524288
    s_mov_b32 s27, 0x20000
    s_lshr_b32 s5, s4, 1
    s_lshl_b32 s5, s5, 2
    v_or_b32 v51, s5, v50
    v_lshlrev_b32 v51, 1, v51
    v_xor_b32 v51, v51, v49
    v_lshlrev_b32 v51, 4, v51
    s_lshl_b32 s5, s4, 2
    v_add_u32 v52, s5, v50
    v_lshl_add_u32 v51, v52, 10, v51
    s_and_b32 s6, s47, 3
    s_lshl_b32 s5, s6, 8
    v_add_u32 v15, s5, v51
    s_and_b32 s6, s47, 3
    s_add_u32 s5, s6, 0
    s_and_b32 s5, s5, 3
    s_lshl_b32 s32, s5, 17
    s_lshl_b32 s36, s5, 21
    s_add_u32 s5, s6, 1
    s_and_b32 s5, s5, 3
    s_lshl_b32 s33, s5, 17
    s_lshl_b32 s37, s5, 21
    s_add_u32 s5, s6, 2
    s_and_b32 s5, s5, 3
    s_lshl_b32 s34, s5, 17
    s_lshl_b32 s38, s5, 21
    s_add_u32 s5, s6, 3
    s_and_b32 s5, s5, 3
    s_lshl_b32 s35, s5, 17
    s_lshl_b32 s39, s5, 21
    s_barrier
    ds_read_b64_tr_b16 a[0:1], v5 offset:16384
    ds_read_b64_tr_b16 a[2:3], v5 offset:17408
    ds_read_b64_tr_b16 a[4:5], v3 offset:16384
    ds_read_b64_tr_b16 a[6:7], v3 offset:17408
    ds_read_b128 v[16:19], v1 offset:0
    ds_read_b128 v[20:23], v1 offset:512
    ds_read_b128 v[24:27], v1 offset:4096
    ds_read_b128 v[28:31], v1 offset:4608
    ds_read_b128 v[32:35], v1 offset:8192
    ds_read_b128 v[36:39], v1 offset:8704
    ds_read_b64_tr_b16 a[8:9], v5 offset:24576
    ds_read_b64_tr_b16 a[10:11], v5 offset:25600
    ds_read_b64_tr_b16 a[12:13], v3 offset:24576
    ds_read_b64_tr_b16 a[14:15], v3 offset:25600
    ds_read_b128 v[40:43], v2 offset:0
    s_waitcnt lgkmcnt(10)
    v_mfma_f32_16x16x32_bf16 v[48:51], v[16:19], a[0:3], 0
    ds_read_b128 v[44:47], v2 offset:512
    v_mfma_f32_16x16x32_bf16 v[52:55], v[16:19], a[4:7], 0
    s_waitcnt vmcnt(0) lgkmcnt(10)
    v_mfma_f32_16x16x32_bf16 v[56:59], v[20:23], a[0:3], 0
    ds_read_b128 v[16:19], v2 offset:4096
    v_mfma_f32_16x16x32_bf16 v[60:63], v[20:23], a[4:7], 0
    s_waitcnt lgkmcnt(10)
    v_mfma_f32_16x16x32_bf16 v[64:67], v[24:27], a[0:3], 0
    ds_read_b128 v[20:23], v2 offset:4608
    v_mfma_f32_16x16x32_bf16 v[68:71], v[24:27], a[4:7], 0
    s_waitcnt lgkmcnt(10)
    v_mfma_f32_16x16x32_bf16 v[72:75], v[28:31], a[0:3], 0
    ds_read_b128 v[24:27], v2 offset:8192
    v_mfma_f32_16x16x32_bf16 v[76:79], v[28:31], a[4:7], 0
    s_waitcnt lgkmcnt(10)
    v_mfma_f32_16x16x32_bf16 v[80:83], v[32:35], a[0:3], 0
    ds_read_b128 v[28:31], v2 offset:8704
    v_mfma_f32_16x16x32_bf16 v[84:87], v[32:35], a[4:7], 0
    s_waitcnt lgkmcnt(5)
    v_mfma_f32_16x16x32_bf16 v[88:91], v[36:39], a[0:3], 0
    v_mfma_f32_16x16x32_bf16 v[92:95], v[36:39], a[4:7], 0
    v_mfma_f32_16x16x32_bf16 v[48:51], v[40:43], a[8:11], v[48:51]
    s_waitcnt lgkmcnt(0)
    s_barrier
    v_mfma_f32_16x16x32_bf16 v[52:55], v[40:43], a[12:15], v[52:55]
    ds_read_b64_tr_b16 a[16:17], v5 offset:49152
    ds_read_b64_tr_b16 a[18:19], v5 offset:50176
    ds_read_b64_tr_b16 a[20:21], v3 offset:49152
    v_mfma_f32_16x16x32_bf16 v[56:59], v[44:47], a[8:11], v[56:59]
    ds_read_b64_tr_b16 a[22:23], v3 offset:50176
    ds_read_b128 v[32:35], v1 offset:32768
    v_mfma_f32_16x16x32_bf16 v[60:63], v[44:47], a[12:15], v[60:63]
    ds_read_b128 v[36:39], v1 offset:33280
    v_mfma_f32_16x16x32_bf16 v[64:67], v[16:19], a[8:11], v[64:67]
    ds_read_b128 v[40:43], v1 offset:36864
    ds_read_b128 v[44:47], v1 offset:37376
    v_mfma_f32_16x16x32_bf16 v[68:71], v[16:19], a[12:15], v[68:71]
    v_mfma_f32_16x16x32_bf16 v[72:75], v[20:23], a[8:11], v[72:75]
    ds_read_b128 v[16:19], v1 offset:40960
    v_mfma_f32_16x16x32_bf16 v[76:79], v[20:23], a[12:15], v[76:79]
    v_mfma_f32_16x16x32_bf16 v[80:83], v[24:27], a[8:11], v[80:83]
    ds_read_b128 v[20:23], v1 offset:41472
    ds_read_b64_tr_b16 a[24:25], v5 offset:57344
    v_mfma_f32_16x16x32_bf16 v[84:87], v[24:27], a[12:15], v[84:87]
    ds_read_b64_tr_b16 a[26:27], v5 offset:58368
    v_mfma_f32_16x16x32_bf16 v[88:91], v[28:31], a[8:11], v[88:91]
    ds_read_b64_tr_b16 a[28:29], v3 offset:57344
    ds_read_b64_tr_b16 a[30:31], v3 offset:58368
    v_mfma_f32_16x16x32_bf16 v[92:95], v[28:31], a[12:15], v[92:95]
    ds_read_b128 v[24:27], v2 offset:32768
    s_waitcnt lgkmcnt(10)
    v_mfma_f32_16x16x32_bf16 v[48:51], v[32:35], a[16:19], v[48:51]
    ds_read_b128 v[28:31], v2 offset:33280
    v_mfma_f32_16x16x32_bf16 v[52:55], v[32:35], a[20:23], v[52:55]
    s_waitcnt lgkmcnt(10)
    v_mfma_f32_16x16x32_bf16 v[56:59], v[36:39], a[16:19], v[56:59]
    ds_read_b128 v[32:35], v2 offset:36864
    v_mfma_f32_16x16x32_bf16 v[60:63], v[36:39], a[20:23], v[60:63]
    s_waitcnt lgkmcnt(9)
    v_mfma_f32_16x16x32_bf16 v[64:67], v[40:43], a[16:19], v[64:67]
    ds_read_b128 v[36:39], v2 offset:37376
    v_mfma_f32_16x16x32_bf16 v[68:71], v[40:43], a[20:23], v[68:71]
    v_mfma_f32_16x16x32_bf16 v[72:75], v[44:47], a[16:19], v[72:75]
    ds_read_b128 v[40:43], v2 offset:40960
    v_mfma_f32_16x16x32_bf16 v[76:79], v[44:47], a[20:23], v[76:79]
    s_waitcnt lgkmcnt(7)
    v_mfma_f32_16x16x32_bf16 v[80:83], v[16:19], a[16:19], v[80:83]
    ds_read_b128 v[44:47], v2 offset:41472
    v_mfma_f32_16x16x32_bf16 v[84:87], v[16:19], a[20:23], v[84:87]
    v_mfma_f32_16x16x32_bf16 v[88:91], v[20:23], a[16:19], v[88:91]
    v_add_u32 v1, 0x10000, v1
    v_add_u32 v2, 0x10000, v2
    v_mfma_f32_16x16x32_bf16 v[92:95], v[20:23], a[20:23], v[92:95]
    v_add_u32 v5, 0x10000, v5
    v_add_u32 v3, 0x10000, v3
    s_waitcnt lgkmcnt(4)
    v_mfma_f32_16x16x32_bf16 v[48:51], v[24:27], a[24:27], v[48:51]
    s_waitcnt lgkmcnt(0)
    s_barrier
    v_mfma_f32_16x16x32_bf16 v[52:55], v[24:27], a[28:31], v[52:55]
    ds_read_b64_tr_b16 a[32:33], v5 offset:16384
    ds_read_b64_tr_b16 a[34:35], v5 offset:17408
    ds_read_b64_tr_b16 a[36:37], v3 offset:16384
    v_mfma_f32_16x16x32_bf16 v[56:59], v[28:31], a[24:27], v[56:59]
    ds_read_b64_tr_b16 a[38:39], v3 offset:17408
    ds_read_b128 v[16:19], v1 offset:0
    v_mfma_f32_16x16x32_bf16 v[60:63], v[28:31], a[28:31], v[60:63]
    ds_read_b128 v[20:23], v1 offset:512
    v_mfma_f32_16x16x32_bf16 v[64:67], v[32:35], a[24:27], v[64:67]
    ds_read_b128 v[24:27], v1 offset:4096
    ds_read_b128 v[28:31], v1 offset:4608
    v_mfma_f32_16x16x32_bf16 v[68:71], v[32:35], a[28:31], v[68:71]
    v_mfma_f32_16x16x32_bf16 v[72:75], v[36:39], a[24:27], v[72:75]
    ds_read_b128 v[32:35], v1 offset:8192
    v_mfma_f32_16x16x32_bf16 v[76:79], v[36:39], a[28:31], v[76:79]
    v_mfma_f32_16x16x32_bf16 v[80:83], v[40:43], a[24:27], v[80:83]
    ds_read_b128 v[36:39], v1 offset:8704
    ds_read_b64_tr_b16 a[40:41], v5 offset:24576
    v_mfma_f32_16x16x32_bf16 v[84:87], v[40:43], a[28:31], v[84:87]
    ds_read_b64_tr_b16 a[42:43], v5 offset:25600
    v_mfma_f32_16x16x32_bf16 v[88:91], v[44:47], a[24:27], v[88:91]
    ds_read_b64_tr_b16 a[44:45], v3 offset:24576
    ds_read_b64_tr_b16 a[46:47], v3 offset:25600
    v_mfma_f32_16x16x32_bf16 v[92:95], v[44:47], a[28:31], v[92:95]
    ds_read_b128 v[40:43], v2 offset:0
    s_waitcnt lgkmcnt(10)
    v_mfma_f32_16x16x32_bf16 v[48:51], v[16:19], a[32:35], v[48:51]
    ds_read_b128 v[44:47], v2 offset:512
    v_mfma_f32_16x16x32_bf16 v[52:55], v[16:19], a[36:39], v[52:55]
    s_waitcnt lgkmcnt(10)
    v_mfma_f32_16x16x32_bf16 v[56:59], v[20:23], a[32:35], v[56:59]
    ds_read_b128 v[16:19], v2 offset:4096
    v_mfma_f32_16x16x32_bf16 v[60:63], v[20:23], a[36:39], v[60:63]
    s_waitcnt lgkmcnt(9)
    v_mfma_f32_16x16x32_bf16 v[64:67], v[24:27], a[32:35], v[64:67]
    ds_read_b128 v[20:23], v2 offset:4608
    v_mfma_f32_16x16x32_bf16 v[68:71], v[24:27], a[36:39], v[68:71]
    v_mfma_f32_16x16x32_bf16 v[72:75], v[28:31], a[32:35], v[72:75]
    ds_read_b128 v[24:27], v2 offset:8192
    v_mfma_f32_16x16x32_bf16 v[76:79], v[28:31], a[36:39], v[76:79]
    s_waitcnt lgkmcnt(7)
    v_mfma_f32_16x16x32_bf16 v[80:83], v[32:35], a[32:35], v[80:83]
    ds_read_b128 v[28:31], v2 offset:8704
    v_mfma_f32_16x16x32_bf16 v[84:87], v[32:35], a[36:39], v[84:87]
    v_mfma_f32_16x16x32_bf16 v[88:91], v[36:39], a[32:35], v[88:91]
    v_mfma_f32_16x16x32_bf16 v[92:95], v[36:39], a[36:39], v[92:95]
    s_waitcnt lgkmcnt(4)
    v_mfma_f32_16x16x32_bf16 v[48:51], v[40:43], a[40:43], v[48:51]
    s_waitcnt lgkmcnt(0)
    s_barrier
    v_mfma_f32_16x16x32_bf16 v[52:55], v[40:43], a[44:47], v[52:55]
    ds_read_b64_tr_b16 a[48:49], v5 offset:49152
    ds_read_b64_tr_b16 a[50:51], v5 offset:50176
    ds_read_b64_tr_b16 a[52:53], v3 offset:49152
    v_mfma_f32_16x16x32_bf16 v[56:59], v[44:47], a[40:43], v[56:59]
    ds_read_b64_tr_b16 a[54:55], v3 offset:50176
    ds_read_b128 v[32:35], v1 offset:32768
    v_mfma_f32_16x16x32_bf16 v[60:63], v[44:47], a[44:47], v[60:63]
    ds_read_b128 v[36:39], v1 offset:33280
    v_mfma_f32_16x16x32_bf16 v[64:67], v[16:19], a[40:43], v[64:67]
    ds_read_b128 v[40:43], v1 offset:36864
    ds_read_b128 v[44:47], v1 offset:37376
    v_mfma_f32_16x16x32_bf16 v[68:71], v[16:19], a[44:47], v[68:71]
    v_mfma_f32_16x16x32_bf16 v[72:75], v[20:23], a[40:43], v[72:75]
    ds_read_b128 v[16:19], v1 offset:40960
    v_mfma_f32_16x16x32_bf16 v[76:79], v[20:23], a[44:47], v[76:79]
    v_mfma_f32_16x16x32_bf16 v[80:83], v[24:27], a[40:43], v[80:83]
    ds_read_b128 v[20:23], v1 offset:41472
    ds_read_b64_tr_b16 a[56:57], v5 offset:57344
    v_mfma_f32_16x16x32_bf16 v[84:87], v[24:27], a[44:47], v[84:87]
    ds_read_b64_tr_b16 a[58:59], v5 offset:58368
    v_mfma_f32_16x16x32_bf16 v[88:91], v[28:31], a[40:43], v[88:91]
    ds_read_b64_tr_b16 a[60:61], v3 offset:57344
    ds_read_b64_tr_b16 a[62:63], v3 offset:58368
    v_mfma_f32_16x16x32_bf16 v[92:95], v[28:31], a[44:47], v[92:95]
    ds_read_b128 v[24:27], v2 offset:32768
    s_waitcnt lgkmcnt(10)
    v_mfma_f32_16x16x32_bf16 v[48:51], v[32:35], a[48:51], v[48:51]
    ds_read_b128 v[28:31], v2 offset:33280
    v_mfma_f32_16x16x32_bf16 v[52:55], v[32:35], a[52:55], v[52:55]
    s_waitcnt lgkmcnt(10)
    v_mfma_f32_16x16x32_bf16 v[56:59], v[36:39], a[48:51], v[56:59]
    ds_read_b128 v[32:35], v2 offset:36864
    v_mfma_f32_16x16x32_bf16 v[60:63], v[36:39], a[52:55], v[60:63]
    s_waitcnt lgkmcnt(9)
    v_mfma_f32_16x16x32_bf16 v[64:67], v[40:43], a[48:51], v[64:67]
    ds_read_b128 v[36:39], v2 offset:37376
    v_mfma_f32_16x16x32_bf16 v[68:71], v[40:43], a[52:55], v[68:71]
    v_mfma_f32_16x16x32_bf16 v[72:75], v[44:47], a[48:51], v[72:75]
    ds_read_b128 v[40:43], v2 offset:40960
    v_mfma_f32_16x16x32_bf16 v[76:79], v[44:47], a[52:55], v[76:79]
    s_waitcnt lgkmcnt(7)
    v_mfma_f32_16x16x32_bf16 v[80:83], v[16:19], a[48:51], v[80:83]
    ds_read_b128 v[44:47], v2 offset:41472
    v_mfma_f32_16x16x32_bf16 v[84:87], v[16:19], a[52:55], v[84:87]
    v_mfma_f32_16x16x32_bf16 v[88:91], v[20:23], a[48:51], v[88:91]
    v_add_u32 v1, 0xffff0000, v1
    v_add_u32 v2, 0xffff0000, v2
    v_mfma_f32_16x16x32_bf16 v[92:95], v[20:23], a[52:55], v[92:95]
    v_add_u32 v5, 0xffff0000, v5
    v_add_u32 v3, 0xffff0000, v3
    s_waitcnt lgkmcnt(4)
    v_mfma_f32_16x16x32_bf16 v[48:51], v[24:27], a[56:59], v[48:51]
    s_waitcnt lgkmcnt(0)
    s_barrier
    v_mfma_f32_16x16x32_bf16 v[52:55], v[24:27], a[60:63], v[52:55]
    ds_read_b64_tr_b16 a[64:65], v5 offset:16384
    ds_read_b64_tr_b16 a[66:67], v5 offset:17408
    ds_read_b64_tr_b16 a[68:69], v3 offset:16384
    v_mfma_f32_16x16x32_bf16 v[56:59], v[28:31], a[56:59], v[56:59]
    ds_read_b64_tr_b16 a[70:71], v3 offset:17408
    ds_read_b128 v[16:19], v1 offset:0
    v_mfma_f32_16x16x32_bf16 v[60:63], v[28:31], a[60:63], v[60:63]
    ds_read_b128 v[20:23], v1 offset:512
    v_mfma_f32_16x16x32_bf16 v[64:67], v[32:35], a[56:59], v[64:67]
    ds_read_b128 v[24:27], v1 offset:4096
    ds_read_b128 v[28:31], v1 offset:4608
    v_mfma_f32_16x16x32_bf16 v[68:71], v[32:35], a[60:63], v[68:71]
    v_mfma_f32_16x16x32_bf16 v[72:75], v[36:39], a[56:59], v[72:75]
    ds_read_b128 v[32:35], v1 offset:8192
    v_mfma_f32_16x16x32_bf16 v[76:79], v[36:39], a[60:63], v[76:79]
    v_mfma_f32_16x16x32_bf16 v[80:83], v[40:43], a[56:59], v[80:83]
    ds_read_b128 v[36:39], v1 offset:8704
    ds_read_b64_tr_b16 a[72:73], v5 offset:24576
    v_mfma_f32_16x16x32_bf16 v[84:87], v[40:43], a[60:63], v[84:87]
    ds_read_b64_tr_b16 a[74:75], v5 offset:25600
    v_mfma_f32_16x16x32_bf16 v[88:91], v[44:47], a[56:59], v[88:91]
    ds_read_b64_tr_b16 a[76:77], v3 offset:24576
    ds_read_b64_tr_b16 a[78:79], v3 offset:25600
    v_mfma_f32_16x16x32_bf16 v[92:95], v[44:47], a[60:63], v[92:95]
    ds_read_b128 v[40:43], v2 offset:0
    s_waitcnt lgkmcnt(10)
    v_mfma_f32_16x16x32_bf16 v[48:51], v[16:19], a[64:67], v[48:51]
    ds_read_b128 v[44:47], v2 offset:512
    v_mfma_f32_16x16x32_bf16 v[52:55], v[16:19], a[68:71], v[52:55]
    s_waitcnt lgkmcnt(10)
    v_mfma_f32_16x16x32_bf16 v[56:59], v[20:23], a[64:67], v[56:59]
    ds_read_b128 v[16:19], v2 offset:4096
    v_mfma_f32_16x16x32_bf16 v[60:63], v[20:23], a[68:71], v[60:63]
    s_waitcnt lgkmcnt(9)
    v_mfma_f32_16x16x32_bf16 v[64:67], v[24:27], a[64:67], v[64:67]
    ds_read_b128 v[20:23], v2 offset:4608
    v_mfma_f32_16x16x32_bf16 v[68:71], v[24:27], a[68:71], v[68:71]
    v_mfma_f32_16x16x32_bf16 v[72:75], v[28:31], a[64:67], v[72:75]
    ds_read_b128 v[24:27], v2 offset:8192
    v_mfma_f32_16x16x32_bf16 v[76:79], v[28:31], a[68:71], v[76:79]
    s_waitcnt lgkmcnt(7)
    v_mfma_f32_16x16x32_bf16 v[80:83], v[32:35], a[64:67], v[80:83]
    ds_read_b128 v[28:31], v2 offset:8704
    v_mfma_f32_16x16x32_bf16 v[84:87], v[32:35], a[68:71], v[84:87]
    v_mfma_f32_16x16x32_bf16 v[88:91], v[36:39], a[64:67], v[88:91]
    v_mfma_f32_16x16x32_bf16 v[92:95], v[36:39], a[68:71], v[92:95]
    s_waitcnt lgkmcnt(4)
    v_mfma_f32_16x16x32_bf16 v[48:51], v[40:43], a[72:75], v[48:51]
    s_waitcnt lgkmcnt(0)
    s_barrier
    v_mfma_f32_16x16x32_bf16 v[52:55], v[40:43], a[76:79], v[52:55]
    ds_read_b64_tr_b16 a[80:81], v5 offset:49152
    ds_read_b64_tr_b16 a[82:83], v5 offset:50176
    ds_read_b64_tr_b16 a[84:85], v3 offset:49152
    v_mfma_f32_16x16x32_bf16 v[56:59], v[44:47], a[72:75], v[56:59]
    ds_read_b64_tr_b16 a[86:87], v3 offset:50176
    ds_read_b128 v[32:35], v1 offset:32768
    v_mfma_f32_16x16x32_bf16 v[60:63], v[44:47], a[76:79], v[60:63]
    ds_read_b128 v[36:39], v1 offset:33280
    v_mfma_f32_16x16x32_bf16 v[64:67], v[16:19], a[72:75], v[64:67]
    ds_read_b128 v[40:43], v1 offset:36864
    ds_read_b128 v[44:47], v1 offset:37376
    v_mfma_f32_16x16x32_bf16 v[68:71], v[16:19], a[76:79], v[68:71]
    v_mfma_f32_16x16x32_bf16 v[72:75], v[20:23], a[72:75], v[72:75]
    ds_read_b128 v[16:19], v1 offset:40960
    v_mfma_f32_16x16x32_bf16 v[76:79], v[20:23], a[76:79], v[76:79]
    v_mfma_f32_16x16x32_bf16 v[80:83], v[24:27], a[72:75], v[80:83]
    ds_read_b128 v[20:23], v1 offset:41472
    ds_read_b64_tr_b16 a[88:89], v5 offset:57344
    v_mfma_f32_16x16x32_bf16 v[84:87], v[24:27], a[76:79], v[84:87]
    ds_read_b64_tr_b16 a[90:91], v5 offset:58368
    v_mfma_f32_16x16x32_bf16 v[88:91], v[28:31], a[72:75], v[88:91]
    ds_read_b64_tr_b16 a[92:93], v3 offset:57344
    ds_read_b64_tr_b16 a[94:95], v3 offset:58368
    v_mfma_f32_16x16x32_bf16 v[92:95], v[28:31], a[76:79], v[92:95]
    ds_read_b128 v[24:27], v2 offset:32768
    s_waitcnt lgkmcnt(10)
    v_mfma_f32_16x16x32_bf16 v[48:51], v[32:35], a[80:83], v[48:51]
    ds_read_b128 v[28:31], v2 offset:33280
    v_mfma_f32_16x16x32_bf16 v[52:55], v[32:35], a[84:87], v[52:55]
    s_waitcnt lgkmcnt(10)
    v_mfma_f32_16x16x32_bf16 v[56:59], v[36:39], a[80:83], v[56:59]
    ds_read_b128 v[32:35], v2 offset:36864
    v_mfma_f32_16x16x32_bf16 v[60:63], v[36:39], a[84:87], v[60:63]
    s_waitcnt lgkmcnt(9)
    v_mfma_f32_16x16x32_bf16 v[64:67], v[40:43], a[80:83], v[64:67]
    ds_read_b128 v[36:39], v2 offset:37376
    v_mfma_f32_16x16x32_bf16 v[68:71], v[40:43], a[84:87], v[68:71]
    v_mfma_f32_16x16x32_bf16 v[72:75], v[44:47], a[80:83], v[72:75]
    ds_read_b128 v[40:43], v2 offset:40960
    v_mfma_f32_16x16x32_bf16 v[76:79], v[44:47], a[84:87], v[76:79]
    s_waitcnt lgkmcnt(7)
    v_mfma_f32_16x16x32_bf16 v[80:83], v[16:19], a[80:83], v[80:83]
    ds_read_b128 v[44:47], v2 offset:41472
    v_mfma_f32_16x16x32_bf16 v[84:87], v[16:19], a[84:87], v[84:87]
    v_mfma_f32_16x16x32_bf16 v[88:91], v[20:23], a[80:83], v[88:91]
    v_add_u32 v1, 0x10000, v1
    v_add_u32 v2, 0x10000, v2
    v_mfma_f32_16x16x32_bf16 v[92:95], v[20:23], a[84:87], v[92:95]
    v_add_u32 v5, 0x10000, v5
    v_add_u32 v3, 0x10000, v3
    s_waitcnt lgkmcnt(4)
    v_mfma_f32_16x16x32_bf16 v[48:51], v[24:27], a[88:91], v[48:51]
    s_waitcnt lgkmcnt(0)
    s_barrier
    v_mfma_f32_16x16x32_bf16 v[52:55], v[24:27], a[92:95], v[52:55]
    ds_read_b64_tr_b16 a[96:97], v5 offset:16384
    ds_read_b64_tr_b16 a[98:99], v5 offset:17408
    ds_read_b64_tr_b16 a[100:101], v3 offset:16384
    v_mfma_f32_16x16x32_bf16 v[56:59], v[28:31], a[88:91], v[56:59]
    ds_read_b64_tr_b16 a[102:103], v3 offset:17408
    ds_read_b128 v[16:19], v1 offset:0
    v_mfma_f32_16x16x32_bf16 v[60:63], v[28:31], a[92:95], v[60:63]
    ds_read_b128 v[20:23], v1 offset:512
    v_mfma_f32_16x16x32_bf16 v[64:67], v[32:35], a[88:91], v[64:67]
    ds_read_b128 v[24:27], v1 offset:4096
    ds_read_b128 v[28:31], v1 offset:4608
    v_mfma_f32_16x16x32_bf16 v[68:71], v[32:35], a[92:95], v[68:71]
    v_mfma_f32_16x16x32_bf16 v[72:75], v[36:39], a[88:91], v[72:75]
    ds_read_b128 v[32:35], v1 offset:8192
    v_mfma_f32_16x16x32_bf16 v[76:79], v[36:39], a[92:95], v[76:79]
    v_mfma_f32_16x16x32_bf16 v[80:83], v[40:43], a[88:91], v[80:83]
    ds_read_b128 v[36:39], v1 offset:8704
    ds_read_b64_tr_b16 a[104:105], v5 offset:24576
    v_mfma_f32_16x16x32_bf16 v[84:87], v[40:43], a[92:95], v[84:87]
    ds_read_b64_tr_b16 a[106:107], v5 offset:25600
    v_mfma_f32_16x16x32_bf16 v[88:91], v[44:47], a[88:91], v[88:91]
    ds_read_b64_tr_b16 a[108:109], v3 offset:24576
    ds_read_b64_tr_b16 a[110:111], v3 offset:25600
    v_mfma_f32_16x16x32_bf16 v[92:95], v[44:47], a[92:95], v[92:95]
    ds_read_b128 v[40:43], v2 offset:0
    s_waitcnt lgkmcnt(10)
    v_mfma_f32_16x16x32_bf16 v[48:51], v[16:19], a[96:99], v[48:51]
    ds_read_b128 v[44:47], v2 offset:512
    v_mfma_f32_16x16x32_bf16 v[52:55], v[16:19], a[100:103], v[52:55]
    s_waitcnt lgkmcnt(10)
    v_mfma_f32_16x16x32_bf16 v[56:59], v[20:23], a[96:99], v[56:59]
    ds_read_b128 v[16:19], v2 offset:4096
    v_mfma_f32_16x16x32_bf16 v[60:63], v[20:23], a[100:103], v[60:63]
    s_waitcnt lgkmcnt(9)
    v_mfma_f32_16x16x32_bf16 v[64:67], v[24:27], a[96:99], v[64:67]
    ds_read_b128 v[20:23], v2 offset:4608
    v_mfma_f32_16x16x32_bf16 v[68:71], v[24:27], a[100:103], v[68:71]
    v_mfma_f32_16x16x32_bf16 v[72:75], v[28:31], a[96:99], v[72:75]
    ds_read_b128 v[24:27], v2 offset:8192
    v_mfma_f32_16x16x32_bf16 v[76:79], v[28:31], a[100:103], v[76:79]
    s_waitcnt lgkmcnt(7)
    v_mfma_f32_16x16x32_bf16 v[80:83], v[32:35], a[96:99], v[80:83]
    ds_read_b128 v[28:31], v2 offset:8704
    v_mfma_f32_16x16x32_bf16 v[84:87], v[32:35], a[100:103], v[84:87]
    v_mfma_f32_16x16x32_bf16 v[88:91], v[36:39], a[96:99], v[88:91]
    v_mfma_f32_16x16x32_bf16 v[92:95], v[36:39], a[100:103], v[92:95]
    s_waitcnt lgkmcnt(4)
    v_mfma_f32_16x16x32_bf16 v[48:51], v[40:43], a[104:107], v[48:51]
    s_waitcnt lgkmcnt(0)
    s_barrier
    v_mfma_f32_16x16x32_bf16 v[52:55], v[40:43], a[108:111], v[52:55]
    ds_read_b64_tr_b16 a[112:113], v5 offset:49152
    ds_read_b64_tr_b16 a[114:115], v5 offset:50176
    ds_read_b64_tr_b16 a[116:117], v3 offset:49152
    v_mfma_f32_16x16x32_bf16 v[56:59], v[44:47], a[104:107], v[56:59]
    ds_read_b64_tr_b16 a[118:119], v3 offset:50176
    ds_read_b128 v[32:35], v1 offset:32768
    v_mfma_f32_16x16x32_bf16 v[60:63], v[44:47], a[108:111], v[60:63]
    ds_read_b128 v[36:39], v1 offset:33280
    v_mfma_f32_16x16x32_bf16 v[64:67], v[16:19], a[104:107], v[64:67]
    ds_read_b128 v[40:43], v1 offset:36864
    ds_read_b128 v[44:47], v1 offset:37376
    v_mfma_f32_16x16x32_bf16 v[68:71], v[16:19], a[108:111], v[68:71]
    v_mfma_f32_16x16x32_bf16 v[72:75], v[20:23], a[104:107], v[72:75]
    ds_read_b128 v[16:19], v1 offset:40960
    v_mfma_f32_16x16x32_bf16 v[76:79], v[20:23], a[108:111], v[76:79]
    v_mfma_f32_16x16x32_bf16 v[80:83], v[24:27], a[104:107], v[80:83]
    ds_read_b128 v[20:23], v1 offset:41472
    ds_read_b64_tr_b16 a[120:121], v5 offset:57344
    v_mfma_f32_16x16x32_bf16 v[84:87], v[24:27], a[108:111], v[84:87]
    ds_read_b64_tr_b16 a[122:123], v5 offset:58368
    v_mfma_f32_16x16x32_bf16 v[88:91], v[28:31], a[104:107], v[88:91]
    ds_read_b64_tr_b16 a[124:125], v3 offset:57344
    ds_read_b64_tr_b16 a[126:127], v3 offset:58368
    v_mfma_f32_16x16x32_bf16 v[92:95], v[28:31], a[108:111], v[92:95]
    ds_read_b128 v[24:27], v2 offset:32768
    s_waitcnt lgkmcnt(10)
    v_mfma_f32_16x16x32_bf16 v[48:51], v[32:35], a[112:115], v[48:51]
    ds_read_b128 v[28:31], v2 offset:33280
    v_mfma_f32_16x16x32_bf16 v[52:55], v[32:35], a[116:119], v[52:55]
    s_waitcnt lgkmcnt(10)
    v_mfma_f32_16x16x32_bf16 v[56:59], v[36:39], a[112:115], v[56:59]
    ds_read_b128 v[32:35], v2 offset:36864
    v_mfma_f32_16x16x32_bf16 v[60:63], v[36:39], a[116:119], v[60:63]
    s_waitcnt lgkmcnt(9)
    v_mfma_f32_16x16x32_bf16 v[64:67], v[40:43], a[112:115], v[64:67]
    ds_read_b128 v[36:39], v2 offset:37376
    v_mfma_f32_16x16x32_bf16 v[68:71], v[40:43], a[116:119], v[68:71]
    v_mfma_f32_16x16x32_bf16 v[72:75], v[44:47], a[112:115], v[72:75]
    ds_read_b128 v[40:43], v2 offset:40960
    v_mfma_f32_16x16x32_bf16 v[76:79], v[44:47], a[116:119], v[76:79]
    s_waitcnt lgkmcnt(7)
    v_mfma_f32_16x16x32_bf16 v[80:83], v[16:19], a[112:115], v[80:83]
    ds_read_b128 v[44:47], v2 offset:41472
    v_mfma_f32_16x16x32_bf16 v[84:87], v[16:19], a[116:119], v[84:87]
    v_mfma_f32_16x16x32_bf16 v[88:91], v[20:23], a[112:115], v[88:91]
    v_add_u32 v1, 0xffff0000, v1
    v_add_u32 v2, 0xffff0000, v2
    v_mfma_f32_16x16x32_bf16 v[92:95], v[20:23], a[116:119], v[92:95]
    s_waitcnt lgkmcnt(4)
    v_mfma_f32_16x16x32_bf16 v[48:51], v[24:27], a[120:123], v[48:51]
    s_waitcnt lgkmcnt(0)
    s_barrier
    v_mfma_f32_16x16x32_bf16 v[52:55], v[24:27], a[124:127], v[52:55]
    ds_read_b128 v[16:19], v1 offset:0
    ds_read_b128 v[20:23], v1 offset:512
    v_mfma_f32_16x16x32_bf16 v[56:59], v[28:31], a[120:123], v[56:59]
    ds_read_b128 v[24:27], v2 offset:0
    v_mfma_f32_16x16x32_bf16 v[60:63], v[28:31], a[124:127], v[60:63]
    v_mfma_f32_16x16x32_bf16 v[64:67], v[32:35], a[120:123], v[64:67]
    ds_read_b128 v[28:31], v2 offset:512
    v_mfma_f32_16x16x32_bf16 v[68:71], v[32:35], a[124:127], v[68:71]
    v_mfma_f32_16x16x32_bf16 v[72:75], v[36:39], a[120:123], v[72:75]
    ds_read_b128 v[32:35], v1 offset:4096
    v_mfma_f32_16x16x32_bf16 v[76:79], v[36:39], a[124:127], v[76:79]
    v_mfma_f32_16x16x32_bf16 v[80:83], v[40:43], a[120:123], v[80:83]
    ds_read_b128 v[36:39], v1 offset:4608
    v_mfma_f32_16x16x32_bf16 v[84:87], v[40:43], a[124:127], v[84:87]
    v_mfma_f32_16x16x32_bf16 v[88:91], v[44:47], a[120:123], v[88:91]
    ds_read_b128 v[40:43], v2 offset:4096
    v_mfma_f32_16x16x32_bf16 v[92:95], v[44:47], a[124:127], v[92:95]
    s_waitcnt lgkmcnt(5)
    v_mfma_f32_16x16x32_bf16 v[96:99], v[16:19], a[0:3], 0
    ds_read_b128 v[44:47], v2 offset:4608
    s_nop 1
    v_mul_f32 v84, s72, v84
    v_mfma_f32_16x16x32_bf16 v[100:103], v[16:19], a[4:7], 0
    v_mul_f32 v85, s72, v85
    v_mul_f32 v86, s72, v86
    v_mul_f32 v87, s72, v87
    v_mfma_f32_16x16x32_bf16 v[104:107], v[20:23], a[0:3], 0
    ds_read_b128 v[16:19], v1 offset:8192
    v_mfma_f32_16x16x32_bf16 v[108:111], v[20:23], a[4:7], 0
    v_exp_f32 v84, v84
    v_exp_f32 v85, v85
    s_waitcnt lgkmcnt(4)
    v_mfma_f32_16x16x32_bf16 v[96:99], v[24:27], a[8:11], v[96:99]
    ds_read_b128 v[20:23], v1 offset:8704
    v_mfma_f32_16x16x32_bf16 v[100:103], v[24:27], a[12:15], v[100:103]
    v_exp_f32 v86, v86
    v_exp_f32 v87, v87
    v_mfma_f32_16x16x32_bf16 v[104:107], v[28:31], a[8:11], v[104:107]
    ds_read_b128 v[24:27], v2 offset:8192
    v_add_f32 v84, 1.0, v84
    v_mfma_f32_16x16x32_bf16 v[108:111], v[28:31], a[12:15], v[108:111]
    v_add_f32 v85, 1.0, v85
    v_add_f32 v86, 1.0, v86
    v_add_f32 v87, 1.0, v87
    v_mfma_f32_16x16x32_bf16 v[96:99], v[32:35], a[16:19], v[96:99]
    ds_read_b128 v[28:31], v2 offset:8704
    v_mfma_f32_16x16x32_bf16 v[100:103], v[32:35], a[20:23], v[100:103]
    v_rcp_f32 v84, v84
    v_rcp_f32 v85, v85
    s_waitcnt lgkmcnt(4)
    v_mfma_f32_16x16x32_bf16 v[104:107], v[36:39], a[16:19], v[104:107]
    ds_read_b128 v[32:35], v1 offset:12288
    v_mfma_f32_16x16x32_bf16 v[108:111], v[36:39], a[20:23], v[108:111]
    v_rcp_f32 v86, v86
    v_rcp_f32 v87, v87
    v_mfma_f32_16x16x32_bf16 v[96:99], v[40:43], a[24:27], v[96:99]
    ds_read_b128 v[36:39], v1 offset:12800
    v_mul_f32 v80, v80, v84
    v_mfma_f32_16x16x32_bf16 v[100:103], v[40:43], a[28:31], v[100:103]
    v_mul_f32 v81, v81, v85
    v_mul_f32 v82, v82, v86
    v_mul_f32 v83, v83, v87
    v_mfma_f32_16x16x32_bf16 v[104:107], v[44:47], a[24:27], v[104:107]
    ds_read_b128 v[40:43], v2 offset:12288
    v_cvt_pk_bf16_f32 v84, v80, v81
    v_mfma_f32_16x16x32_bf16 v[108:111], v[44:47], a[28:31], v[108:111]
    v_cvt_pk_bf16_f32 v85, v82, v83
    v_mul_f32 v92, s72, v92
    s_waitcnt lgkmcnt(4)
    v_mfma_f32_16x16x32_bf16 v[96:99], v[16:19], a[32:35], v[96:99]
    ds_read_b128 v[44:47], v2 offset:12800
    v_mul_f32 v93, s72, v93
    v_mfma_f32_16x16x32_bf16 v[100:103], v[16:19], a[36:39], v[100:103]
    v_mul_f32 v94, s72, v94
    v_mul_f32 v95, s72, v95
    v_mfma_f32_16x16x32_bf16 v[104:107], v[20:23], a[32:35], v[104:107]
    ds_read_b128 v[16:19], v1 offset:16384
    v_mfma_f32_16x16x32_bf16 v[108:111], v[20:23], a[36:39], v[108:111]
    v_exp_f32 v92, v92
    v_exp_f32 v93, v93
    v_mfma_f32_16x16x32_bf16 v[96:99], v[24:27], a[40:43], v[96:99]
    ds_read_b128 v[20:23], v1 offset:16896
    v_mfma_f32_16x16x32_bf16 v[100:103], v[24:27], a[44:47], v[100:103]
    v_exp_f32 v94, v94
    v_exp_f32 v95, v95
    s_waitcnt lgkmcnt(4)
    v_mfma_f32_16x16x32_bf16 v[104:107], v[28:31], a[40:43], v[104:107]
    ds_read_b128 v[24:27], v2 offset:16384
    v_add_f32 v92, 1.0, v92
    v_mfma_f32_16x16x32_bf16 v[108:111], v[28:31], a[44:47], v[108:111]
    v_add_f32 v93, 1.0, v93
    v_add_f32 v94, 1.0, v94
    v_add_f32 v95, 1.0, v95
    v_mfma_f32_16x16x32_bf16 v[96:99], v[32:35], a[48:51], v[96:99]
    ds_read_b128 v[28:31], v2 offset:16896
    v_mfma_f32_16x16x32_bf16 v[100:103], v[32:35], a[52:55], v[100:103]
    v_rcp_f32 v92, v92
    v_rcp_f32 v93, v93
    v_mfma_f32_16x16x32_bf16 v[104:107], v[36:39], a[48:51], v[104:107]
    ds_read_b128 v[32:35], v1 offset:20480
    v_mfma_f32_16x16x32_bf16 v[108:111], v[36:39], a[52:55], v[108:111]
    v_rcp_f32 v94, v94
    v_rcp_f32 v95, v95
    s_waitcnt lgkmcnt(4)
    v_mfma_f32_16x16x32_bf16 v[96:99], v[40:43], a[56:59], v[96:99]
    ds_read_b128 v[36:39], v1 offset:20992
    v_mul_f32 v88, v88, v92
    v_mfma_f32_16x16x32_bf16 v[100:103], v[40:43], a[60:63], v[100:103]
    v_mul_f32 v89, v89, v93
    v_mul_f32 v90, v90, v94
    v_mul_f32 v91, v91, v95
    v_mfma_f32_16x16x32_bf16 v[104:107], v[44:47], a[56:59], v[104:107]
    ds_read_b128 v[40:43], v2 offset:20480
    v_cvt_pk_bf16_f32 v86, v88, v89
    v_mfma_f32_16x16x32_bf16 v[108:111], v[44:47], a[60:63], v[108:111]
    v_cvt_pk_bf16_f32 v87, v90, v91
    v_mul_f32 v52, s72, v52
    v_mfma_f32_16x16x32_bf16 v[96:99], v[16:19], a[64:67], v[96:99]
    ds_read_b128 v[44:47], v2 offset:20992
    v_mul_f32 v53, s72, v53
    v_mfma_f32_16x16x32_bf16 v[100:103], v[16:19], a[68:71], v[100:103]
    v_mul_f32 v54, s72, v54
    v_mul_f32 v55, s72, v55
    s_waitcnt lgkmcnt(4)
    v_mfma_f32_16x16x32_bf16 v[104:107], v[20:23], a[64:67], v[104:107]
    ds_read_b128 v[16:19], v1 offset:24576
    v_mfma_f32_16x16x32_bf16 v[108:111], v[20:23], a[68:71], v[108:111]
    v_exp_f32 v52, v52
    v_exp_f32 v53, v53
    v_mfma_f32_16x16x32_bf16 v[96:99], v[24:27], a[72:75], v[96:99]
    ds_read_b128 v[20:23], v1 offset:25088
    v_mfma_f32_16x16x32_bf16 v[100:103], v[24:27], a[76:79], v[100:103]
    v_exp_f32 v54, v54
    v_exp_f32 v55, v55
    v_mfma_f32_16x16x32_bf16 v[104:107], v[28:31], a[72:75], v[104:107]
    ds_read_b128 v[24:27], v2 offset:24576
    v_add_f32 v52, 1.0, v52
    v_mfma_f32_16x16x32_bf16 v[108:111], v[28:31], a[76:79], v[108:111]
    v_add_f32 v53, 1.0, v53
    v_add_f32 v54, 1.0, v54
    v_add_f32 v55, 1.0, v55
    s_waitcnt lgkmcnt(4)
    v_mfma_f32_16x16x32_bf16 v[96:99], v[32:35], a[80:83], v[96:99]
    ds_read_b128 v[28:31], v2 offset:25088
    v_mfma_f32_16x16x32_bf16 v[100:103], v[32:35], a[84:87], v[100:103]
    v_rcp_f32 v52, v52
    v_rcp_f32 v53, v53
    v_mfma_f32_16x16x32_bf16 v[104:107], v[36:39], a[80:83], v[104:107]
    ds_read_b128 v[32:35], v1 offset:28672
    v_mfma_f32_16x16x32_bf16 v[108:111], v[36:39], a[84:87], v[108:111]
    v_rcp_f32 v54, v54
    v_rcp_f32 v55, v55
    v_mfma_f32_16x16x32_bf16 v[96:99], v[40:43], a[88:91], v[96:99]
    ds_read_b128 v[36:39], v1 offset:29184
    v_mul_f32 v48, v48, v52
    v_mfma_f32_16x16x32_bf16 v[100:103], v[40:43], a[92:95], v[100:103]
    v_mul_f32 v49, v49, v53
    v_mul_f32 v50, v50, v54
    v_mul_f32 v51, v51, v55
    s_waitcnt lgkmcnt(4)
    v_mfma_f32_16x16x32_bf16 v[104:107], v[44:47], a[88:91], v[104:107]
    ds_read_b128 v[40:43], v2 offset:28672
    v_cvt_pk_bf16_f32 v80, v48, v49
    v_mfma_f32_16x16x32_bf16 v[108:111], v[44:47], a[92:95], v[108:111]
    v_cvt_pk_bf16_f32 v81, v50, v51
    v_mul_f32 v60, s72, v60
    v_mfma_f32_16x16x32_bf16 v[96:99], v[16:19], a[96:99], v[96:99]
    ds_read_b128 v[44:47], v2 offset:29184
    v_mul_f32 v61, s72, v61
    v_mfma_f32_16x16x32_bf16 v[100:103], v[16:19], a[100:103], v[100:103]
    v_mul_f32 v62, s72, v62
    v_mul_f32 v63, s72, v63
    v_mfma_f32_16x16x32_bf16 v[104:107], v[20:23], a[96:99], v[104:107]
    v_exp_f32 v60, v60
    v_mfma_f32_16x16x32_bf16 v[108:111], v[20:23], a[100:103], v[108:111]
    v_exp_f32 v61, v61
    v_add_f32 v60, 1.0, v60
    s_waitcnt lgkmcnt(3)
    v_mfma_f32_16x16x32_bf16 v[96:99], v[24:27], a[104:107], v[96:99]
    s_waitcnt lgkmcnt(0)
    s_barrier
    v_mfma_f32_16x16x32_bf16 v[100:103], v[24:27], a[108:111], v[100:103]
    ds_read_b128 v[16:19], v1 offset:32768
    ds_read_b128 v[20:23], v1 offset:33280
    v_add_f32 v61, 1.0, v61
    v_mfma_f32_16x16x32_bf16 v[104:107], v[28:31], a[104:107], v[104:107]
    ds_read_b128 v[24:27], v2 offset:32768
    v_mfma_f32_16x16x32_bf16 v[108:111], v[28:31], a[108:111], v[108:111]
    v_exp_f32 v62, v62
    v_exp_f32 v63, v63
    v_mfma_f32_16x16x32_bf16 v[96:99], v[32:35], a[112:115], v[96:99]
    ds_read_b128 v[28:31], v2 offset:33280
    v_add_f32 v62, 1.0, v62
    v_mfma_f32_16x16x32_bf16 v[100:103], v[32:35], a[116:119], v[100:103]
    v_add_f32 v63, 1.0, v63
    v_rcp_f32 v60, v60
    v_mfma_f32_16x16x32_bf16 v[104:107], v[36:39], a[112:115], v[104:107]
    ds_read_b128 v[32:35], v1 offset:36864
    v_mfma_f32_16x16x32_bf16 v[108:111], v[36:39], a[116:119], v[108:111]
    v_rcp_f32 v61, v61
    v_rcp_f32 v62, v62
    v_mfma_f32_16x16x32_bf16 v[96:99], v[40:43], a[120:123], v[96:99]
    ds_read_b128 v[36:39], v1 offset:37376
    v_mfma_f32_16x16x32_bf16 v[100:103], v[40:43], a[124:127], v[100:103]
    v_rcp_f32 v63, v63
    v_mul_f32 v56, v56, v60
    v_mul_f32 v57, v57, v61
    v_mfma_f32_16x16x32_bf16 v[104:107], v[44:47], a[120:123], v[104:107]
    ds_read_b128 v[40:43], v2 offset:36864
    v_mul_f32 v58, v58, v62
    v_mfma_f32_16x16x32_bf16 v[108:111], v[44:47], a[124:127], v[108:111]
    v_mul_f32 v59, v59, v63
    v_cvt_pk_bf16_f32 v82, v56, v57
    s_waitcnt lgkmcnt(4)
    v_mfma_f32_16x16x32_bf16 v[112:115], v[16:19], a[0:3], 0
    ds_read_b128 v[44:47], v2 offset:37376
    v_mfma_f32_16x16x32_bf16 v[116:119], v[16:19], a[4:7], 0
    v_cvt_pk_bf16_f32 v83, v58, v59
    v_mul_f32 v68, s72, v68
    v_mul_f32 v69, s72, v69
    v_mfma_f32_16x16x32_bf16 v[120:123], v[20:23], a[0:3], 0
    ds_read_b128 v[16:19], v1 offset:40960
    v_mul_f32 v70, s72, v70
    v_mfma_f32_16x16x32_bf16 v[124:127], v[20:23], a[4:7], 0
    v_mul_f32 v71, s72, v71
    v_exp_f32 v68, v68
    v_mfma_f32_16x16x32_bf16 v[112:115], v[24:27], a[8:11], v[112:115]
    ds_read_b128 v[20:23], v1 offset:41472
    v_mfma_f32_16x16x32_bf16 v[116:119], v[24:27], a[12:15], v[116:119]
    v_exp_f32 v69, v69
    v_exp_f32 v70, v70
    s_waitcnt lgkmcnt(4)
    v_mfma_f32_16x16x32_bf16 v[120:123], v[28:31], a[8:11], v[120:123]
    ds_read_b128 v[24:27], v2 offset:40960
    v_mfma_f32_16x16x32_bf16 v[124:127], v[28:31], a[12:15], v[124:127]
    v_exp_f32 v71, v71
    v_add_f32 v68, 1.0, v68
    v_add_f32 v69, 1.0, v69
    v_mfma_f32_16x16x32_bf16 v[112:115], v[32:35], a[16:19], v[112:115]
    ds_read_b128 v[28:31], v2 offset:41472
    v_add_f32 v70, 1.0, v70
    v_mfma_f32_16x16x32_bf16 v[116:119], v[32:35], a[20:23], v[116:119]
    v_add_f32 v71, 1.0, v71
    v_rcp_f32 v68, v68
    v_mfma_f32_16x16x32_bf16 v[120:123], v[36:39], a[16:19], v[120:123]
    ds_read_b128 v[32:35], v1 offset:45056
    v_mfma_f32_16x16x32_bf16 v[124:127], v[36:39], a[20:23], v[124:127]
    v_rcp_f32 v69, v69
    v_rcp_f32 v70, v70
    s_waitcnt lgkmcnt(4)
    v_mfma_f32_16x16x32_bf16 v[112:115], v[40:43], a[24:27], v[112:115]
    ds_read_b128 v[36:39], v1 offset:45568
    v_mfma_f32_16x16x32_bf16 v[116:119], v[40:43], a[28:31], v[116:119]
    v_rcp_f32 v71, v71
    v_mul_f32 v64, v64, v68
    v_mul_f32 v65, v65, v69
    v_mfma_f32_16x16x32_bf16 v[120:123], v[44:47], a[24:27], v[120:123]
    ds_read_b128 v[40:43], v2 offset:45056
    v_mul_f32 v66, v66, v70
    v_mfma_f32_16x16x32_bf16 v[124:127], v[44:47], a[28:31], v[124:127]
    v_mul_f32 v67, v67, v71
    v_cvt_pk_bf16_f32 v88, v64, v65
    v_mfma_f32_16x16x32_bf16 v[112:115], v[16:19], a[32:35], v[112:115]
    ds_read_b128 v[44:47], v2 offset:45568
    v_mfma_f32_16x16x32_bf16 v[116:119], v[16:19], a[36:39], v[116:119]
    v_cvt_pk_bf16_f32 v89, v66, v67
    v_mul_f32 v76, s72, v76
    v_mul_f32 v77, s72, v77
    s_waitcnt lgkmcnt(4)
    v_mfma_f32_16x16x32_bf16 v[120:123], v[20:23], a[32:35], v[120:123]
    ds_read_b128 v[16:19], v1 offset:49152
    v_mul_f32 v78, s72, v78
    v_mfma_f32_16x16x32_bf16 v[124:127], v[20:23], a[36:39], v[124:127]
    v_mul_f32 v79, s72, v79
    v_exp_f32 v76, v76
    v_mfma_f32_16x16x32_bf16 v[112:115], v[24:27], a[40:43], v[112:115]
    ds_read_b128 v[20:23], v1 offset:49664
    v_mfma_f32_16x16x32_bf16 v[116:119], v[24:27], a[44:47], v[116:119]
    v_exp_f32 v77, v77
    v_exp_f32 v78, v78
    v_mfma_f32_16x16x32_bf16 v[120:123], v[28:31], a[40:43], v[120:123]
    ds_read_b128 v[24:27], v2 offset:49152
    v_mfma_f32_16x16x32_bf16 v[124:127], v[28:31], a[44:47], v[124:127]
    v_exp_f32 v79, v79
    v_add_f32 v76, 1.0, v76
    v_add_f32 v77, 1.0, v77
    s_waitcnt lgkmcnt(4)
    v_mfma_f32_16x16x32_bf16 v[112:115], v[32:35], a[48:51], v[112:115]
    ds_read_b128 v[28:31], v2 offset:49664
    v_add_f32 v78, 1.0, v78
    v_mfma_f32_16x16x32_bf16 v[116:119], v[32:35], a[52:55], v[116:119]
    v_add_f32 v79, 1.0, v79
    v_rcp_f32 v76, v76
    v_mfma_f32_16x16x32_bf16 v[120:123], v[36:39], a[48:51], v[120:123]
    ds_read_b128 v[32:35], v1 offset:53248
    v_mfma_f32_16x16x32_bf16 v[124:127], v[36:39], a[52:55], v[124:127]
    v_rcp_f32 v77, v77
    v_rcp_f32 v78, v78
    v_mfma_f32_16x16x32_bf16 v[112:115], v[40:43], a[56:59], v[112:115]
    ds_read_b128 v[36:39], v1 offset:53760
    v_mfma_f32_16x16x32_bf16 v[116:119], v[40:43], a[60:63], v[116:119]
    v_rcp_f32 v79, v79
    v_mul_f32 v72, v72, v76
    v_mul_f32 v73, v73, v77
    s_waitcnt lgkmcnt(4)
    v_mfma_f32_16x16x32_bf16 v[120:123], v[44:47], a[56:59], v[120:123]
    ds_read_b128 v[40:43], v2 offset:53248
    v_mul_f32 v74, v74, v78
    v_mfma_f32_16x16x32_bf16 v[124:127], v[44:47], a[60:63], v[124:127]
    v_mul_f32 v75, v75, v79
    v_cvt_pk_bf16_f32 v90, v72, v73
    v_mfma_f32_16x16x32_bf16 v[112:115], v[16:19], a[64:67], v[112:115]
    ds_read_b128 v[44:47], v2 offset:53760
    v_mfma_f32_16x16x32_bf16 v[116:119], v[16:19], a[68:71], v[116:119]
    v_cvt_pk_bf16_f32 v91, v74, v75
    v_mul_f32 v100, s72, v100
    v_mul_f32 v101, s72, v101
    v_mfma_f32_16x16x32_bf16 v[120:123], v[20:23], a[64:67], v[120:123]
    ds_read_b128 v[16:19], v1 offset:57344
    v_mul_f32 v102, s72, v102
    v_mfma_f32_16x16x32_bf16 v[124:127], v[20:23], a[68:71], v[124:127]
    v_mul_f32 v103, s72, v103
    v_exp_f32 v100, v100
    s_waitcnt lgkmcnt(4)
    v_mfma_f32_16x16x32_bf16 v[112:115], v[24:27], a[72:75], v[112:115]
    ds_read_b128 v[20:23], v1 offset:57856
    v_mfma_f32_16x16x32_bf16 v[116:119], v[24:27], a[76:79], v[116:119]
    v_exp_f32 v101, v101
    v_exp_f32 v102, v102
    v_mfma_f32_16x16x32_bf16 v[120:123], v[28:31], a[72:75], v[120:123]
    ds_read_b128 v[24:27], v2 offset:57344
    v_mfma_f32_16x16x32_bf16 v[124:127], v[28:31], a[76:79], v[124:127]
    v_exp_f32 v103, v103
    v_add_f32 v100, 1.0, v100
    v_add_f32 v101, 1.0, v101
    v_mfma_f32_16x16x32_bf16 v[112:115], v[32:35], a[80:83], v[112:115]
    ds_read_b128 v[28:31], v2 offset:57856
    v_add_f32 v102, 1.0, v102
    v_mfma_f32_16x16x32_bf16 v[116:119], v[32:35], a[84:87], v[116:119]
    v_add_f32 v103, 1.0, v103
    v_rcp_f32 v100, v100
    s_waitcnt lgkmcnt(4)
    v_mfma_f32_16x16x32_bf16 v[120:123], v[36:39], a[80:83], v[120:123]
    ds_read_b128 v[32:35], v1 offset:61440
    v_mfma_f32_16x16x32_bf16 v[124:127], v[36:39], a[84:87], v[124:127]
    v_rcp_f32 v101, v101
    v_rcp_f32 v102, v102
    v_mfma_f32_16x16x32_bf16 v[112:115], v[40:43], a[88:91], v[112:115]
    ds_read_b128 v[36:39], v1 offset:61952
    v_mfma_f32_16x16x32_bf16 v[116:119], v[40:43], a[92:95], v[116:119]
    v_rcp_f32 v103, v103
    v_mul_f32 v96, v96, v100
    v_mul_f32 v97, v97, v101
    v_mfma_f32_16x16x32_bf16 v[120:123], v[44:47], a[88:91], v[120:123]
    ds_read_b128 v[40:43], v2 offset:61440
    v_mul_f32 v98, v98, v102
    v_mfma_f32_16x16x32_bf16 v[124:127], v[44:47], a[92:95], v[124:127]
    v_mul_f32 v99, v99, v103
    v_cvt_pk_bf16_f32 v100, v96, v97
    s_waitcnt lgkmcnt(4)
    v_mfma_f32_16x16x32_bf16 v[112:115], v[16:19], a[96:99], v[112:115]
    ds_read_b128 v[44:47], v2 offset:61952
    v_mfma_f32_16x16x32_bf16 v[116:119], v[16:19], a[100:103], v[116:119]
    v_cvt_pk_bf16_f32 v101, v98, v99
    v_mul_f32 v108, s72, v108
    v_mul_f32 v109, s72, v109
    v_mfma_f32_16x16x32_bf16 v[120:123], v[20:23], a[96:99], v[120:123]
    v_add_u32 v1, 0x10000, v1
    v_add_u32 v2, 0x10000, v2
    v_mfma_f32_16x16x32_bf16 v[124:127], v[20:23], a[100:103], v[124:127]
    v_mul_f32 v110, s72, v110
    v_mul_f32 v111, s72, v111
    v_mfma_f32_16x16x32_bf16 v[112:115], v[24:27], a[104:107], v[112:115]
    s_waitcnt lgkmcnt(0)
    s_barrier
    v_mfma_f32_16x16x32_bf16 v[116:119], v[24:27], a[108:111], v[116:119]
    ds_read_b128 v[16:19], v1 offset:0
    ds_read_b128 v[20:23], v1 offset:512
    v_mfma_f32_16x16x32_bf16 v[120:123], v[28:31], a[104:107], v[120:123]
    ds_read_b128 v[24:27], v2 offset:0
    v_mfma_f32_16x16x32_bf16 v[124:127], v[28:31], a[108:111], v[124:127]
    v_exp_f32 v108, v108
    v_exp_f32 v109, v109
    v_mfma_f32_16x16x32_bf16 v[112:115], v[32:35], a[112:115], v[112:115]
    ds_read_b128 v[28:31], v2 offset:512
    v_mfma_f32_16x16x32_bf16 v[116:119], v[32:35], a[116:119], v[116:119]
    v_exp_f32 v110, v110
    v_exp_f32 v111, v111
    v_mfma_f32_16x16x32_bf16 v[120:123], v[36:39], a[112:115], v[120:123]
    ds_read_b128 v[32:35], v1 offset:4096
    v_add_f32 v108, 1.0, v108
    v_mfma_f32_16x16x32_bf16 v[124:127], v[36:39], a[116:119], v[124:127]
    v_add_f32 v109, 1.0, v109
    v_add_f32 v110, 1.0, v110
    v_add_f32 v111, 1.0, v111
    v_mfma_f32_16x16x32_bf16 v[112:115], v[40:43], a[120:123], v[112:115]
    ds_read_b128 v[36:39], v1 offset:4608
    v_mfma_f32_16x16x32_bf16 v[116:119], v[40:43], a[124:127], v[116:119]
    v_rcp_f32 v108, v108
    v_rcp_f32 v109, v109
    v_mfma_f32_16x16x32_bf16 v[120:123], v[44:47], a[120:123], v[120:123]
    ds_read_b128 v[40:43], v2 offset:4096
    v_mfma_f32_16x16x32_bf16 v[124:127], v[44:47], a[124:127], v[124:127]
    v_rcp_f32 v110, v110
    v_rcp_f32 v111, v111
    s_waitcnt lgkmcnt(4)
    v_mfma_f32_16x16x32_bf16 v[48:51], v[16:19], a[0:3], 0
    ds_read_b128 v[44:47], v2 offset:4608
    v_mul_f32 v104, v104, v108
    v_mul_f32 v105, v105, v109
    v_mfma_f32_16x16x32_bf16 v[52:55], v[16:19], a[4:7], 0
    v_mul_f32 v106, v106, v110
    v_mul_f32 v107, v107, v111
    v_cvt_pk_bf16_f32 v102, v104, v105
    v_cvt_pk_bf16_f32 v103, v106, v107
    v_mfma_f32_16x16x32_bf16 v[56:59], v[20:23], a[0:3], 0
    ds_read_b128 v[16:19], v1 offset:8192
    v_mul_f32 v116, s72, v116
    v_mul_f32 v117, s72, v117
    v_mfma_f32_16x16x32_bf16 v[60:63], v[20:23], a[4:7], 0
    v_mul_f32 v118, s72, v118
    v_mul_f32 v119, s72, v119
    v_exp_f32 v116, v116
    v_mfma_f32_16x16x32_bf16 v[48:51], v[24:27], a[8:11], v[48:51]
    ds_read_b128 v[20:23], v1 offset:8704
    v_exp_f32 v117, v117
    v_mfma_f32_16x16x32_bf16 v[52:55], v[24:27], a[12:15], v[52:55]
    v_exp_f32 v118, v118
    v_exp_f32 v119, v119
    v_add_f32 v116, 1.0, v116
    s_waitcnt lgkmcnt(3)
    v_mfma_f32_16x16x32_bf16 v[56:59], v[28:31], a[8:11], v[56:59]
    ds_read_b128 v[24:27], v2 offset:8192
    v_add_f32 v117, 1.0, v117
    v_add_f32 v118, 1.0, v118
    v_add_f32 v119, 1.0, v119
    v_mfma_f32_16x16x32_bf16 v[60:63], v[28:31], a[12:15], v[60:63]
    v_rcp_f32 v116, v116
    v_rcp_f32 v117, v117
    v_mfma_f32_16x16x32_bf16 v[48:51], v[32:35], a[16:19], v[48:51]
    ds_read_b128 v[28:31], v2 offset:8704
    v_rcp_f32 v118, v118
    v_mfma_f32_16x16x32_bf16 v[52:55], v[32:35], a[20:23], v[52:55]
    v_rcp_f32 v119, v119
    v_mul_f32 v112, v112, v116
    v_mul_f32 v113, v113, v117
    v_mul_f32 v114, v114, v118
    v_mfma_f32_16x16x32_bf16 v[56:59], v[36:39], a[16:19], v[56:59]
    ds_read_b128 v[32:35], v1 offset:12288
    v_mul_f32 v115, v115, v119
    v_cvt_pk_bf16_f32 v116, v112, v113
    v_mfma_f32_16x16x32_bf16 v[60:63], v[36:39], a[20:23], v[60:63]
    v_cvt_pk_bf16_f32 v117, v114, v115
    v_mul_f32 v124, s72, v124
    v_mul_f32 v125, s72, v125
    v_mul_f32 v126, s72, v126
    v_mfma_f32_16x16x32_bf16 v[48:51], v[40:43], a[24:27], v[48:51]
    ds_read_b128 v[36:39], v1 offset:12800
    v_mul_f32 v127, s72, v127
    v_exp_f32 v124, v124
    v_mfma_f32_16x16x32_bf16 v[52:55], v[40:43], a[28:31], v[52:55]
    v_exp_f32 v125, v125
    v_exp_f32 v126, v126
    s_waitcnt lgkmcnt(3)
    v_mfma_f32_16x16x32_bf16 v[56:59], v[44:47], a[24:27], v[56:59]
    ds_read_b128 v[40:43], v2 offset:12288
    v_exp_f32 v127, v127
    v_mfma_f32_16x16x32_bf16 v[60:63], v[44:47], a[28:31], v[60:63]
    v_add_f32 v124, 1.0, v124
    v_add_f32 v125, 1.0, v125
    v_add_f32 v126, 1.0, v126
    v_add_f32 v127, 1.0, v127
    v_mfma_f32_16x16x32_bf16 v[48:51], v[16:19], a[32:35], v[48:51]
    ds_read_b128 v[44:47], v2 offset:12800
    v_rcp_f32 v124, v124
    v_mfma_f32_16x16x32_bf16 v[52:55], v[16:19], a[36:39], v[52:55]
    v_rcp_f32 v125, v125
    ds_write_b128 v6, v[80:83] offset:0
    v_mfma_f32_16x16x32_bf16 v[56:59], v[20:23], a[32:35], v[56:59]
    ds_read_b128 v[16:19], v1 offset:16384
    v_mfma_f32_16x16x32_bf16 v[60:63], v[20:23], a[36:39], v[60:63]
    ds_write_b128 v6, v[88:91] offset:64
    ds_write_b128 v6, v[84:87] offset:128
    v_mfma_f32_16x16x32_bf16 v[48:51], v[24:27], a[40:43], v[48:51]
    ds_read_b128 v[20:23], v1 offset:16896
    ds_write_b128 v6, v[100:103] offset:192
    v_mfma_f32_16x16x32_bf16 v[52:55], v[24:27], a[44:47], v[52:55]
    v_rcp_f32 v126, v126
    v_rcp_f32 v127, v127
    s_waitcnt lgkmcnt(7)
    v_mfma_f32_16x16x32_bf16 v[56:59], v[28:31], a[40:43], v[56:59]
    ds_read_b128 v[24:27], v2 offset:16384
    v_mul_f32 v120, v120, v124
    v_mul_f32 v121, v121, v125
    v_mfma_f32_16x16x32_bf16 v[60:63], v[28:31], a[44:47], v[60:63]
    v_mul_f32 v122, v122, v126
    v_mul_f32 v123, v123, v127
    v_cvt_pk_bf16_f32 v118, v120, v121
    v_cvt_pk_bf16_f32 v119, v122, v123
    v_mfma_f32_16x16x32_bf16 v[48:51], v[32:35], a[48:51], v[48:51]
    ds_read_b128 v[28:31], v2 offset:16896
    v_mfma_f32_16x16x32_bf16 v[52:55], v[32:35], a[52:55], v[52:55]
    ds_write_b128 v6, v[116:119] offset:256
    v_mfma_f32_16x16x32_bf16 v[56:59], v[36:39], a[48:51], v[56:59]
    ds_read_b128 v[32:35], v1 offset:20480
    v_mfma_f32_16x16x32_bf16 v[60:63], v[36:39], a[52:55], v[60:63]
    v_mfma_f32_16x16x32_bf16 v[48:51], v[40:43], a[56:59], v[48:51]
    ds_read_b128 v[36:39], v1 offset:20992
    s_waitcnt lgkmcnt(2)
    v_mfma_f32_16x16x32_bf16 v[52:55], v[40:43], a[60:63], v[52:55]
    s_barrier
    v_mfma_f32_16x16x32_bf16 v[56:59], v[44:47], a[56:59], v[56:59]
    ds_read_b128 v[40:43], v2 offset:20480
    v_mfma_f32_16x16x32_bf16 v[60:63], v[44:47], a[60:63], v[60:63]
    v_mfma_f32_16x16x32_bf16 v[48:51], v[16:19], a[64:67], v[48:51]
    ds_read_b128 v[44:47], v2 offset:20992
    v_mfma_f32_16x16x32_bf16 v[52:55], v[16:19], a[68:71], v[52:55]
    v_mfma_f32_16x16x32_bf16 v[56:59], v[20:23], a[64:67], v[56:59]
    ds_read_b128 v[16:19], v1 offset:24576
    v_mfma_f32_16x16x32_bf16 v[60:63], v[20:23], a[68:71], v[60:63]
    v_mfma_f32_16x16x32_bf16 v[48:51], v[24:27], a[72:75], v[48:51]
    ds_read_b128 v[20:23], v1 offset:25088
    v_mfma_f32_16x16x32_bf16 v[52:55], v[24:27], a[76:79], v[52:55]
    v_mfma_f32_16x16x32_bf16 v[56:59], v[28:31], a[72:75], v[56:59]
    ds_read_b128 v[24:27], v2 offset:24576
    v_mfma_f32_16x16x32_bf16 v[60:63], v[28:31], a[76:79], v[60:63]
    s_waitcnt lgkmcnt(5)
    v_mfma_f32_16x16x32_bf16 v[48:51], v[32:35], a[80:83], v[48:51]
    ds_read_b128 v[28:31], v2 offset:25088
    v_mfma_f32_16x16x32_bf16 v[52:55], v[32:35], a[84:87], v[52:55]
    v_mfma_f32_16x16x32_bf16 v[56:59], v[36:39], a[80:83], v[56:59]
    ds_read_b128 v[32:35], v1 offset:28672
    v_mfma_f32_16x16x32_bf16 v[60:63], v[36:39], a[84:87], v[60:63]
    s_waitcnt lgkmcnt(5)
    v_mfma_f32_16x16x32_bf16 v[48:51], v[40:43], a[88:91], v[48:51]
    ds_read_b128 v[36:39], v1 offset:29184
    v_mfma_f32_16x16x32_bf16 v[52:55], v[40:43], a[92:95], v[52:55]
    v_mfma_f32_16x16x32_bf16 v[56:59], v[44:47], a[88:91], v[56:59]
    ds_read_b128 v[40:43], v2 offset:28672
    v_mfma_f32_16x16x32_bf16 v[60:63], v[44:47], a[92:95], v[60:63]
    s_waitcnt lgkmcnt(5)
    v_mfma_f32_16x16x32_bf16 v[48:51], v[16:19], a[96:99], v[48:51]
    ds_read_b128 v[44:47], v2 offset:29184
    v_mfma_f32_16x16x32_bf16 v[52:55], v[16:19], a[100:103], v[52:55]
    v_mfma_f32_16x16x32_bf16 v[56:59], v[20:23], a[96:99], v[56:59]
    v_mfma_f32_16x16x32_bf16 v[60:63], v[20:23], a[100:103], v[60:63]
    s_waitcnt lgkmcnt(4)
    v_mfma_f32_16x16x32_bf16 v[48:51], v[24:27], a[104:107], v[48:51]
    s_waitcnt lgkmcnt(0)
    s_barrier
    v_mfma_f32_16x16x32_bf16 v[52:55], v[24:27], a[108:111], v[52:55]
    ds_read_b128 v[16:19], v1 offset:32768
    ds_read_b128 v[20:23], v1 offset:33280
    v_mfma_f32_16x16x32_bf16 v[56:59], v[28:31], a[104:107], v[56:59]
    ds_read_b128 v[24:27], v2 offset:32768
    v_mfma_f32_16x16x32_bf16 v[60:63], v[28:31], a[108:111], v[60:63]
    v_mfma_f32_16x16x32_bf16 v[48:51], v[32:35], a[112:115], v[48:51]
    ds_read_b128 v[28:31], v2 offset:33280
    v_mfma_f32_16x16x32_bf16 v[52:55], v[32:35], a[116:119], v[52:55]
    v_mfma_f32_16x16x32_bf16 v[56:59], v[36:39], a[112:115], v[56:59]
    ds_read_b128 v[32:35], v1 offset:36864
    v_mfma_f32_16x16x32_bf16 v[60:63], v[36:39], a[116:119], v[60:63]
    v_mfma_f32_16x16x32_bf16 v[48:51], v[40:43], a[120:123], v[48:51]
    ds_read_b128 v[36:39], v1 offset:37376
    v_mfma_f32_16x16x32_bf16 v[52:55], v[40:43], a[124:127], v[52:55]
    v_mfma_f32_16x16x32_bf16 v[56:59], v[44:47], a[120:123], v[56:59]
    ds_read_b128 v[40:43], v2 offset:36864
    v_mfma_f32_16x16x32_bf16 v[60:63], v[44:47], a[124:127], v[60:63]
    s_waitcnt lgkmcnt(5)
    v_mfma_f32_16x16x32_bf16 v[64:67], v[16:19], a[0:3], 0
    ds_read_b128 v[44:47], v2 offset:37376
    v_mfma_f32_16x16x32_bf16 v[68:71], v[16:19], a[4:7], 0
    v_mfma_f32_16x16x32_bf16 v[72:75], v[20:23], a[0:3], 0
    ds_read_b128 v[16:19], v1 offset:40960
    v_mfma_f32_16x16x32_bf16 v[76:79], v[20:23], a[4:7], 0
    s_waitcnt lgkmcnt(5)
    v_mfma_f32_16x16x32_bf16 v[64:67], v[24:27], a[8:11], v[64:67]
    ds_read_b128 v[20:23], v1 offset:41472
    v_mfma_f32_16x16x32_bf16 v[68:71], v[24:27], a[12:15], v[68:71]
    v_mfma_f32_16x16x32_bf16 v[72:75], v[28:31], a[8:11], v[72:75]
    ds_read_b128 v[24:27], v2 offset:40960
    v_mfma_f32_16x16x32_bf16 v[76:79], v[28:31], a[12:15], v[76:79]
    s_waitcnt lgkmcnt(5)
    v_mfma_f32_16x16x32_bf16 v[64:67], v[32:35], a[16:19], v[64:67]
    ds_read_b128 v[28:31], v2 offset:41472
    v_mfma_f32_16x16x32_bf16 v[68:71], v[32:35], a[20:23], v[68:71]
    v_mfma_f32_16x16x32_bf16 v[72:75], v[36:39], a[16:19], v[72:75]
    ds_read_b128 v[32:35], v1 offset:45056
    v_mfma_f32_16x16x32_bf16 v[76:79], v[36:39], a[20:23], v[76:79]
    s_waitcnt lgkmcnt(5)
    v_mfma_f32_16x16x32_bf16 v[64:67], v[40:43], a[24:27], v[64:67]
    ds_read_b128 v[36:39], v1 offset:45568
    v_mfma_f32_16x16x32_bf16 v[68:71], v[40:43], a[28:31], v[68:71]
    v_mfma_f32_16x16x32_bf16 v[72:75], v[44:47], a[24:27], v[72:75]
    ds_read_b128 v[40:43], v2 offset:45056
    v_mfma_f32_16x16x32_bf16 v[76:79], v[44:47], a[28:31], v[76:79]
    s_waitcnt lgkmcnt(5)
    v_mfma_f32_16x16x32_bf16 v[64:67], v[16:19], a[32:35], v[64:67]
    ds_read_b128 v[44:47], v2 offset:45568
    v_mfma_f32_16x16x32_bf16 v[68:71], v[16:19], a[36:39], v[68:71]
    v_mfma_f32_16x16x32_bf16 v[72:75], v[20:23], a[32:35], v[72:75]
    ds_read_b128 v[16:19], v1 offset:49152
    v_mfma_f32_16x16x32_bf16 v[76:79], v[20:23], a[36:39], v[76:79]
    s_waitcnt lgkmcnt(5)
    v_mfma_f32_16x16x32_bf16 v[64:67], v[24:27], a[40:43], v[64:67]
    ds_read_b128 v[20:23], v1 offset:49664
    v_mfma_f32_16x16x32_bf16 v[68:71], v[24:27], a[44:47], v[68:71]
    v_mfma_f32_16x16x32_bf16 v[72:75], v[28:31], a[40:43], v[72:75]
    ds_read_b128 v[24:27], v2 offset:49152
    v_mfma_f32_16x16x32_bf16 v[76:79], v[28:31], a[44:47], v[76:79]
    s_waitcnt lgkmcnt(5)
    v_mfma_f32_16x16x32_bf16 v[64:67], v[32:35], a[48:51], v[64:67]
    ds_read_b128 v[28:31], v2 offset:49664
    v_mfma_f32_16x16x32_bf16 v[68:71], v[32:35], a[52:55], v[68:71]
    v_mfma_f32_16x16x32_bf16 v[72:75], v[36:39], a[48:51], v[72:75]
    ds_read_b128 v[32:35], v1 offset:53248
    v_mfma_f32_16x16x32_bf16 v[76:79], v[36:39], a[52:55], v[76:79]
    s_waitcnt lgkmcnt(5)
    v_mfma_f32_16x16x32_bf16 v[64:67], v[40:43], a[56:59], v[64:67]
    ds_read_b128 v[36:39], v1 offset:53760
    v_mfma_f32_16x16x32_bf16 v[68:71], v[40:43], a[60:63], v[68:71]
    v_mfma_f32_16x16x32_bf16 v[72:75], v[44:47], a[56:59], v[72:75]
    ds_read_b128 v[40:43], v2 offset:53248
    v_mfma_f32_16x16x32_bf16 v[76:79], v[44:47], a[60:63], v[76:79]
    s_waitcnt lgkmcnt(5)
    v_mfma_f32_16x16x32_bf16 v[64:67], v[16:19], a[64:67], v[64:67]
    ds_read_b128 v[44:47], v2 offset:53760
    v_mfma_f32_16x16x32_bf16 v[68:71], v[16:19], a[68:71], v[68:71]
    v_mfma_f32_16x16x32_bf16 v[72:75], v[20:23], a[64:67], v[72:75]
    ds_read_b128 v[16:19], v1 offset:57344
    v_mfma_f32_16x16x32_bf16 v[76:79], v[20:23], a[68:71], v[76:79]
    s_waitcnt lgkmcnt(5)
    v_mfma_f32_16x16x32_bf16 v[64:67], v[24:27], a[72:75], v[64:67]
    ds_read_b128 v[20:23], v1 offset:57856
    v_mfma_f32_16x16x32_bf16 v[68:71], v[24:27], a[76:79], v[68:71]
    v_mfma_f32_16x16x32_bf16 v[72:75], v[28:31], a[72:75], v[72:75]
    ds_read_b128 v[24:27], v2 offset:57344
    v_mfma_f32_16x16x32_bf16 v[76:79], v[28:31], a[76:79], v[76:79]
    s_waitcnt lgkmcnt(5)
    v_mfma_f32_16x16x32_bf16 v[64:67], v[32:35], a[80:83], v[64:67]
    ds_read_b128 v[28:31], v2 offset:57856
    v_mfma_f32_16x16x32_bf16 v[68:71], v[32:35], a[84:87], v[68:71]
    v_mfma_f32_16x16x32_bf16 v[72:75], v[36:39], a[80:83], v[72:75]
    ds_read_b128 v[32:35], v1 offset:61440
    v_mfma_f32_16x16x32_bf16 v[76:79], v[36:39], a[84:87], v[76:79]
    s_waitcnt lgkmcnt(5)
    v_mfma_f32_16x16x32_bf16 v[64:67], v[40:43], a[88:91], v[64:67]
    ds_read_b128 v[36:39], v1 offset:61952
    v_mfma_f32_16x16x32_bf16 v[68:71], v[40:43], a[92:95], v[68:71]
    v_mfma_f32_16x16x32_bf16 v[72:75], v[44:47], a[88:91], v[72:75]
    ds_read_b128 v[40:43], v2 offset:61440
    s_add_u32 m0, s51, 98304
    v_mfma_f32_16x16x32_bf16 v[76:79], v[44:47], a[92:95], v[76:79]
    s_add_u32 s70, s32, 0
    buffer_load_dwordx4 v15, s[24:27], s70 offen lds
    s_waitcnt lgkmcnt(4)
    v_mfma_f32_16x16x32_bf16 v[64:67], v[16:19], a[96:99], v[64:67]
    ds_read_b128 v[44:47], v2 offset:61952
    v_mfma_f32_16x16x32_bf16 v[68:71], v[16:19], a[100:103], v[68:71]
    v_mfma_f32_16x16x32_bf16 v[72:75], v[20:23], a[96:99], v[72:75]
    v_add_u32 v1, 0xffff0000, v1
    v_add_u32 v2, 0xffff0000, v2
    s_add_u32 m0, s51, 102400
    v_mfma_f32_16x16x32_bf16 v[76:79], v[20:23], a[100:103], v[76:79]
    s_add_u32 s70, s32, 16384
    buffer_load_dwordx4 v15, s[24:27], s70 offen lds
    v_mfma_f32_16x16x32_bf16 v[64:67], v[24:27], a[104:107], v[64:67]
    s_waitcnt lgkmcnt(0)
    s_barrier
    v_mfma_f32_16x16x32_bf16 v[68:71], v[24:27], a[108:111], v[68:71]
    ds_read_b128 v[16:19], v1 offset:0
    ds_read_b128 v[20:23], v1 offset:512
    v_mfma_f32_16x16x32_bf16 v[72:75], v[28:31], a[104:107], v[72:75]
    ds_read_b128 v[24:27], v2 offset:0
    s_add_u32 m0, s51, 106496
    v_mfma_f32_16x16x32_bf16 v[76:79], v[28:31], a[108:111], v[76:79]
    s_add_u32 s70, s32, 32768
    buffer_load_dwordx4 v15, s[24:27], s70 offen lds
    v_mfma_f32_16x16x32_bf16 v[64:67], v[32:35], a[112:115], v[64:67]
    ds_read_b128 v[28:31], v2 offset:512
    v_mfma_f32_16x16x32_bf16 v[68:71], v[32:35], a[116:119], v[68:71]
    v_mfma_f32_16x16x32_bf16 v[72:75], v[36:39], a[112:115], v[72:75]
    ds_read_b128 v[32:35], v1 offset:4096
    s_add_u32 m0, s51, 110592
    v_mfma_f32_16x16x32_bf16 v[76:79], v[36:39], a[116:119], v[76:79]
    s_add_u32 s70, s32, 49152
    buffer_load_dwordx4 v15, s[24:27], s70 offen lds
    v_mfma_f32_16x16x32_bf16 v[64:67], v[40:43], a[120:123], v[64:67]
    ds_read_b128 v[36:39], v1 offset:4608
    v_mfma_f32_16x16x32_bf16 v[68:71], v[40:43], a[124:127], v[68:71]
    v_mfma_f32_16x16x32_bf16 v[72:75], v[44:47], a[120:123], v[72:75]
    ds_read_b128 v[40:43], v2 offset:4096
    s_add_u32 m0, s51, 114688
    v_mfma_f32_16x16x32_bf16 v[76:79], v[44:47], a[124:127], v[76:79]
    s_add_u32 s70, s32, 65536
    buffer_load_dwordx4 v15, s[24:27], s70 offen lds
    s_waitcnt lgkmcnt(4)
    v_mfma_f32_16x16x32_bf16 v[80:83], v[16:19], a[0:3], 0
    ds_read_b128 v[44:47], v2 offset:4608
    v_mfma_f32_16x16x32_bf16 v[84:87], v[16:19], a[4:7], 0
    v_mfma_f32_16x16x32_bf16 v[88:91], v[20:23], a[0:3], 0
    ds_read_b128 v[16:19], v1 offset:8192
    s_add_u32 m0, s51, 118784
    v_mfma_f32_16x16x32_bf16 v[92:95], v[20:23], a[4:7], 0
    s_add_u32 s70, s32, 81920
    buffer_load_dwordx4 v15, s[24:27], s70 offen lds
    v_mfma_f32_16x16x32_bf16 v[80:83], v[24:27], a[8:11], v[80:83]
    ds_read_b128 v[20:23], v1 offset:8704
    v_mfma_f32_16x16x32_bf16 v[84:87], v[24:27], a[12:15], v[84:87]
    s_waitcnt lgkmcnt(4)
    v_mfma_f32_16x16x32_bf16 v[88:91], v[28:31], a[8:11], v[88:91]
    ds_read_b128 v[24:27], v2 offset:8192
    s_add_u32 m0, s51, 122880
    v_mfma_f32_16x16x32_bf16 v[92:95], v[28:31], a[12:15], v[92:95]
    s_add_u32 s70, s32, 98304
    buffer_load_dwordx4 v15, s[24:27], s70 offen lds
    v_mfma_f32_16x16x32_bf16 v[80:83], v[32:35], a[16:19], v[80:83]
    ds_read_b128 v[28:31], v2 offset:8704
    v_mfma_f32_16x16x32_bf16 v[84:87], v[32:35], a[20:23], v[84:87]
    v_mfma_f32_16x16x32_bf16 v[88:91], v[36:39], a[16:19], v[88:91]
    ds_read_b128 v[32:35], v1 offset:12288
    s_add_u32 m0, s51, 126976
    v_mfma_f32_16x16x32_bf16 v[92:95], v[36:39], a[20:23], v[92:95]
    s_add_u32 s70, s32, 114688
    buffer_load_dwordx4 v15, s[24:27], s70 offen lds
    s_waitcnt lgkmcnt(4)
    v_mfma_f32_16x16x32_bf16 v[80:83], v[40:43], a[24:27], v[80:83]
    ds_read_b128 v[36:39], v1 offset:12800
    v_mfma_f32_16x16x32_bf16 v[84:87], v[40:43], a[28:31], v[84:87]
    v_mfma_f32_16x16x32_bf16 v[88:91], v[44:47], a[24:27], v[88:91]
    ds_read_b128 v[40:43], v2 offset:12288
    s_add_u32 m0, s51, 131072
    v_mfma_f32_16x16x32_bf16 v[92:95], v[44:47], a[28:31], v[92:95]
    s_add_u32 s70, s33, 0
    buffer_load_dwordx4 v15, s[24:27], s70 offen lds
    v_mfma_f32_16x16x32_bf16 v[80:83], v[16:19], a[32:35], v[80:83]
    ds_read_b128 v[44:47], v2 offset:12800
    v_mfma_f32_16x16x32_bf16 v[84:87], v[16:19], a[36:39], v[84:87]
    s_waitcnt lgkmcnt(4)
    v_mfma_f32_16x16x32_bf16 v[88:91], v[20:23], a[32:35], v[88:91]
    ds_read_b128 v[16:19], v1 offset:16384
    s_add_u32 m0, s51, 135168
    v_mfma_f32_16x16x32_bf16 v[92:95], v[20:23], a[36:39], v[92:95]
    s_add_u32 s70, s33, 16384
    buffer_load_dwordx4 v15, s[24:27], s70 offen lds
    v_mfma_f32_16x16x32_bf16 v[80:83], v[24:27], a[40:43], v[80:83]
    ds_read_b128 v[20:23], v1 offset:16896
    v_mfma_f32_16x16x32_bf16 v[84:87], v[24:27], a[44:47], v[84:87]
    v_mfma_f32_16x16x32_bf16 v[88:91], v[28:31], a[40:43], v[88:91]
    ds_read_b128 v[24:27], v2 offset:16384
    s_add_u32 m0, s51, 139264
    v_mfma_f32_16x16x32_bf16 v[92:95], v[28:31], a[44:47], v[92:95]
    s_add_u32 s70, s33, 32768
    buffer_load_dwordx4 v15, s[24:27], s70 offen lds
    s_waitcnt lgkmcnt(4)
    v_mfma_f32_16x16x32_bf16 v[80:83], v[32:35], a[48:51], v[80:83]
    ds_read_b128 v[28:31], v2 offset:16896
    v_mfma_f32_16x16x32_bf16 v[84:87], v[32:35], a[52:55], v[84:87]
    v_mfma_f32_16x16x32_bf16 v[88:91], v[36:39], a[48:51], v[88:91]
    ds_read_b128 v[32:35], v1 offset:20480
    s_add_u32 m0, s51, 143360
    v_mfma_f32_16x16x32_bf16 v[92:95], v[36:39], a[52:55], v[92:95]
    s_add_u32 s70, s33, 49152
    buffer_load_dwordx4 v15, s[24:27], s70 offen lds
    v_mfma_f32_16x16x32_bf16 v[80:83], v[40:43], a[56:59], v[80:83]
    ds_read_b128 v[36:39], v1 offset:20992
    v_mfma_f32_16x16x32_bf16 v[84:87], v[40:43], a[60:63], v[84:87]
    s_waitcnt lgkmcnt(4)
    v_mfma_f32_16x16x32_bf16 v[88:91], v[44:47], a[56:59], v[88:91]
    ds_read_b128 v[40:43], v2 offset:20480
    s_add_u32 m0, s51, 147456
    v_mfma_f32_16x16x32_bf16 v[92:95], v[44:47], a[60:63], v[92:95]
    s_add_u32 s70, s33, 65536
    buffer_load_dwordx4 v15, s[24:27], s70 offen lds
    v_mfma_f32_16x16x32_bf16 v[80:83], v[16:19], a[64:67], v[80:83]
    ds_read_b128 v[44:47], v2 offset:20992
    v_mul_f32 v52, s72, v52
    v_mfma_f32_16x16x32_bf16 v[84:87], v[16:19], a[68:71], v[84:87]
    v_mul_f32 v53, s72, v53
    v_mul_f32 v54, s72, v54
    v_mul_f32 v55, s72, v55
    v_mfma_f32_16x16x32_bf16 v[88:91], v[20:23], a[64:67], v[88:91]
    ds_read_b128 v[16:19], v1 offset:24576
    s_add_u32 m0, s51, 151552
    v_mfma_f32_16x16x32_bf16 v[92:95], v[20:23], a[68:71], v[92:95]
    s_add_u32 s70, s33, 81920
    buffer_load_dwordx4 v15, s[24:27], s70 offen lds
    s_waitcnt lgkmcnt(4)
    v_mfma_f32_16x16x32_bf16 v[80:83], v[24:27], a[72:75], v[80:83]
    ds_read_b128 v[20:23], v1 offset:25088
    v_exp_f32 v52, v52
    v_mfma_f32_16x16x32_bf16 v[84:87], v[24:27], a[76:79], v[84:87]
    v_exp_f32 v53, v53
    v_add_f32 v52, 1.0, v52
    v_mfma_f32_16x16x32_bf16 v[88:91], v[28:31], a[72:75], v[88:91]
    ds_read_b128 v[24:27], v2 offset:24576
    s_add_u32 m0, s51, 155648
    s_add_u32 s70, s33, 98304
    v_mfma_f32_16x16x32_bf16 v[92:95], v[28:31], a[76:79], v[92:95]
    buffer_load_dwordx4 v15, s[24:27], s70 offen lds
    v_add_f32 v53, 1.0, v53
    v_mfma_f32_16x16x32_bf16 v[80:83], v[32:35], a[80:83], v[80:83]
    ds_read_b128 v[28:31], v2 offset:25088
    v_exp_f32 v54, v54
    v_mfma_f32_16x16x32_bf16 v[84:87], v[32:35], a[84:87], v[84:87]
    v_exp_f32 v55, v55
    v_add_f32 v54, 1.0, v54
    s_waitcnt lgkmcnt(4)
    v_mfma_f32_16x16x32_bf16 v[88:91], v[36:39], a[80:83], v[88:91]
    ds_read_b128 v[32:35], v1 offset:28672
    s_add_u32 m0, s51, 159744
    s_add_u32 s70, s33, 114688
    v_mfma_f32_16x16x32_bf16 v[92:95], v[36:39], a[84:87], v[92:95]
    buffer_load_dwordx4 v15, s[24:27], s70 offen lds
    v_add_f32 v55, 1.0, v55
    v_mfma_f32_16x16x32_bf16 v[80:83], v[40:43], a[88:91], v[80:83]
    ds_read_b128 v[36:39], v1 offset:29184
    v_rcp_f32 v52, v52
    v_mfma_f32_16x16x32_bf16 v[84:87], v[40:43], a[92:95], v[84:87]
    v_rcp_f32 v53, v53
    v_mul_f32 v48, v48, v52
    v_mfma_f32_16x16x32_bf16 v[88:91], v[44:47], a[88:91], v[88:91]
    ds_read_b128 v[40:43], v2 offset:28672
    v_rcp_f32 v54, v54
    v_mfma_f32_16x16x32_bf16 v[92:95], v[44:47], a[92:95], v[92:95]
    v_rcp_f32 v55, v55
    v_mul_f32 v49, v49, v53
    s_waitcnt lgkmcnt(3)
    v_mfma_f32_16x16x32_bf16 v[80:83], v[16:19], a[96:99], v[80:83]
    ds_read_b128 v[44:47], v2 offset:29184
    v_mul_f32 v50, v50, v54
    v_mfma_f32_16x16x32_bf16 v[84:87], v[16:19], a[100:103], v[84:87]
    v_mul_f32 v51, v51, v55
    v_cvt_pk_bf16_f32 v112, v48, v49
    v_cvt_pk_bf16_f32 v113, v50, v51
    v_mfma_f32_16x16x32_bf16 v[88:91], v[20:23], a[96:99], v[88:91]
    v_mul_f32 v60, s72, v60
    v_mul_f32 v61, s72, v61
    v_mul_f32 v62, s72, v62
    v_mfma_f32_16x16x32_bf16 v[92:95], v[20:23], a[100:103], v[92:95]
    v_mul_f32 v63, s72, v63
    v_exp_f32 v60, v60
    v_mfma_f32_16x16x32_bf16 v[80:83], v[24:27], a[104:107], v[80:83]
    s_waitcnt lgkmcnt(0)
    s_barrier
    ds_read_b128 v[16:19], v1 offset:32768
    v_mfma_f32_16x16x32_bf16 v[84:87], v[24:27], a[108:111], v[84:87]
    ds_read_b128 v[20:23], v1 offset:33280
    s_add_u32 m0, s51, 32768
    s_add_u32 s70, s34, 0
    v_mfma_f32_16x16x32_bf16 v[88:91], v[28:31], a[104:107], v[88:91]
    buffer_load_dwordx4 v15, s[24:27], s70 offen lds
    ds_read_b128 v[24:27], v2 offset:32768
    v_mfma_f32_16x16x32_bf16 v[92:95], v[28:31], a[108:111], v[92:95]
    v_exp_f32 v61, v61
    v_add_f32 v60, 1.0, v60
    v_mfma_f32_16x16x32_bf16 v[80:83], v[32:35], a[112:115], v[80:83]
    ds_read_b128 v[28:31], v2 offset:33280
    s_add_u32 m0, s51, 36864
    s_add_u32 s70, s34, 16384
    v_mfma_f32_16x16x32_bf16 v[84:87], v[32:35], a[116:119], v[84:87]
    buffer_load_dwordx4 v15, s[24:27], s70 offen lds
    v_add_f32 v61, 1.0, v61
    v_mfma_f32_16x16x32_bf16 v[88:91], v[36:39], a[112:115], v[88:91]
    ds_read_b128 v[32:35], v1 offset:36864
    v_exp_f32 v62, v62
    v_mfma_f32_16x16x32_bf16 v[92:95], v[36:39], a[116:119], v[92:95]
    v_exp_f32 v63, v63
    v_add_f32 v62, 1.0, v62
    v_mfma_f32_16x16x32_bf16 v[80:83], v[40:43], a[120:123], v[80:83]
    ds_read_b128 v[36:39], v1 offset:37376
    s_add_u32 m0, s51, 40960
    s_add_u32 s70, s34, 32768
    v_mfma_f32_16x16x32_bf16 v[84:87], v[40:43], a[124:127], v[84:87]
    buffer_load_dwordx4 v15, s[24:27], s70 offen lds
    v_add_f32 v63, 1.0, v63
    v_mfma_f32_16x16x32_bf16 v[88:91], v[44:47], a[120:123], v[88:91]
    ds_read_b128 v[40:43], v2 offset:36864
    v_rcp_f32 v60, v60
    v_mfma_f32_16x16x32_bf16 v[92:95], v[44:47], a[124:127], v[92:95]
    v_rcp_f32 v61, v61
    v_mul_f32 v56, v56, v60
    s_waitcnt lgkmcnt(4)
    v_mfma_f32_16x16x32_bf16 v[96:99], v[16:19], a[0:3], 0
    ds_read_b128 v[44:47], v2 offset:37376
    s_add_u32 m0, s51, 45056
    s_add_u32 s70, s34, 49152
    v_mfma_f32_16x16x32_bf16 v[100:103], v[16:19], a[4:7], 0
    buffer_load_dwordx4 v15, s[24:27], s70 offen lds
    v_mul_f32 v57, v57, v61
    v_mfma_f32_16x16x32_bf16 v[104:107], v[20:23], a[0:3], 0
    ds_read_b128 v[16:19], v1 offset:40960
    v_rcp_f32 v62, v62
    v_mfma_f32_16x16x32_bf16 v[108:111], v[20:23], a[4:7], 0
    v_rcp_f32 v63, v63
    v_mul_f32 v58, v58, v62
    v_mfma_f32_16x16x32_bf16 v[96:99], v[24:27], a[8:11], v[96:99]
    ds_read_b128 v[20:23], v1 offset:41472
    s_add_u32 m0, s51, 49152
    s_add_u32 s70, s34, 65536
    v_mfma_f32_16x16x32_bf16 v[100:103], v[24:27], a[12:15], v[100:103]
    buffer_load_dwordx4 v15, s[24:27], s70 offen lds
    v_mul_f32 v59, v59, v63
    s_waitcnt lgkmcnt(3)
    v_mfma_f32_16x16x32_bf16 v[104:107], v[28:31], a[8:11], v[104:107]
    ds_read_b128 v[24:27], v2 offset:40960
    v_cvt_pk_bf16_f32 v114, v56, v57
    v_mfma_f32_16x16x32_bf16 v[108:111], v[28:31], a[12:15], v[108:111]
    v_cvt_pk_bf16_f32 v115, v58, v59
    v_mul_f32 v68, s72, v68
    v_mul_f32 v69, s72, v69
    v_mfma_f32_16x16x32_bf16 v[96:99], v[32:35], a[16:19], v[96:99]
    ds_read_b128 v[28:31], v2 offset:41472
    s_add_u32 m0, s51, 53248
    s_add_u32 s70, s34, 81920
    v_mfma_f32_16x16x32_bf16 v[100:103], v[32:35], a[20:23], v[100:103]
    buffer_load_dwordx4 v15, s[24:27], s70 offen lds
    v_mul_f32 v70, s72, v70
    v_mfma_f32_16x16x32_bf16 v[104:107], v[36:39], a[16:19], v[104:107]
    ds_read_b128 v[32:35], v1 offset:45056
    v_mul_f32 v71, s72, v71
    v_mfma_f32_16x16x32_bf16 v[108:111], v[36:39], a[20:23], v[108:111]
    v_exp_f32 v68, v68
    v_exp_f32 v69, v69
    v_mfma_f32_16x16x32_bf16 v[96:99], v[40:43], a[24:27], v[96:99]
    ds_read_b128 v[36:39], v1 offset:45568
    s_add_u32 m0, s51, 57344
    s_add_u32 s70, s34, 98304
    v_mfma_f32_16x16x32_bf16 v[100:103], v[40:43], a[28:31], v[100:103]
    buffer_load_dwordx4 v15, s[24:27], s70 offen lds
    v_add_f32 v68, 1.0, v68
    s_waitcnt lgkmcnt(4)
    v_mfma_f32_16x16x32_bf16 v[104:107], v[44:47], a[24:27], v[104:107]
    ds_read_b128 v[40:43], v2 offset:45056
    v_exp_f32 v70, v70
    v_mfma_f32_16x16x32_bf16 v[108:111], v[44:47], a[28:31], v[108:111]
    v_exp_f32 v71, v71
    v_add_f32 v69, 1.0, v69
    v_mfma_f32_16x16x32_bf16 v[96:99], v[16:19], a[32:35], v[96:99]
    ds_read_b128 v[44:47], v2 offset:45568
    s_add_u32 m0, s51, 61440
    s_add_u32 s70, s34, 114688
    v_mfma_f32_16x16x32_bf16 v[100:103], v[16:19], a[36:39], v[100:103]
    buffer_load_dwordx4 v15, s[24:27], s70 offen lds
    v_add_f32 v70, 1.0, v70
    v_mfma_f32_16x16x32_bf16 v[104:107], v[20:23], a[32:35], v[104:107]
    ds_read_b128 v[16:19], v1 offset:49152
    v_add_f32 v71, 1.0, v71
    v_mfma_f32_16x16x32_bf16 v[108:111], v[20:23], a[36:39], v[108:111]
    v_rcp_f32 v68, v68
    v_rcp_f32 v69, v69
    s_waitcnt lgkmcnt(3)
    v_mfma_f32_16x16x32_bf16 v[96:99], v[24:27], a[40:43], v[96:99]
    ds_read_b128 v[20:23], v1 offset:49664
    v_rcp_f32 v70, v70
    v_mfma_f32_16x16x32_bf16 v[100:103], v[24:27], a[44:47], v[100:103]
    v_rcp_f32 v71, v71
    v_mul_f32 v64, v64, v68
    v_mfma_f32_16x16x32_bf16 v[104:107], v[28:31], a[40:43], v[104:107]
    ds_read_b128 v[24:27], v2 offset:49152
    v_mul_f32 v65, v65, v69
    v_mfma_f32_16x16x32_bf16 v[108:111], v[28:31], a[44:47], v[108:111]
    v_mul_f32 v66, v66, v70
    v_mul_f32 v67, v67, v71
    v_cvt_pk_bf16_f32 v120, v64, v65
    v_mfma_f32_16x16x32_bf16 v[96:99], v[32:35], a[48:51], v[96:99]
    ds_read_b128 v[28:31], v2 offset:49664
    v_cvt_pk_bf16_f32 v121, v66, v67
    v_mfma_f32_16x16x32_bf16 v[100:103], v[32:35], a[52:55], v[100:103]
    v_mul_f32 v76, s72, v76
    v_mul_f32 v77, s72, v77
    v_mul_f32 v78, s72, v78
    v_mfma_f32_16x16x32_bf16 v[104:107], v[36:39], a[48:51], v[104:107]
    ds_read_b128 v[32:35], v1 offset:53248
    v_mul_f32 v79, s72, v79
    v_mfma_f32_16x16x32_bf16 v[108:111], v[36:39], a[52:55], v[108:111]
    v_exp_f32 v76, v76
    v_exp_f32 v77, v77
    s_waitcnt lgkmcnt(4)
    v_mfma_f32_16x16x32_bf16 v[96:99], v[40:43], a[56:59], v[96:99]
    ds_read_b128 v[36:39], v1 offset:53760
    v_exp_f32 v78, v78
    v_mfma_f32_16x16x32_bf16 v[100:103], v[40:43], a[60:63], v[100:103]
    v_exp_f32 v79, v79
    v_add_f32 v76, 1.0, v76
    v_mfma_f32_16x16x32_bf16 v[104:107], v[44:47], a[56:59], v[104:107]
    ds_read_b128 v[40:43], v2 offset:53248
    v_add_f32 v77, 1.0, v77
    v_add_f32 v78, 1.0, v78
    v_mfma_f32_16x16x32_bf16 v[108:111], v[44:47], a[60:63], v[108:111]
    v_add_f32 v79, 1.0, v79
    v_rcp_f32 v76, v76
    v_mfma_f32_16x16x32_bf16 v[96:99], v[16:19], a[64:67], v[96:99]
    ds_read_b128 v[44:47], v2 offset:53760
    v_rcp_f32 v77, v77
    v_mfma_f32_16x16x32_bf16 v[100:103], v[16:19], a[68:71], v[100:103]
    v_rcp_f32 v78, v78
    v_mul_f32 v72, v72, v76
    s_waitcnt lgkmcnt(3)
    v_mfma_f32_16x16x32_bf16 v[104:107], v[20:23], a[64:67], v[104:107]
    ds_read_b128 v[16:19], v1 offset:57344
    v_rcp_f32 v79, v79
    v_mfma_f32_16x16x32_bf16 v[108:111], v[20:23], a[68:71], v[108:111]
    v_mul_f32 v73, v73, v77
    v_mul_f32 v74, v74, v78
    v_mul_f32 v75, v75, v79
    v_mfma_f32_16x16x32_bf16 v[96:99], v[24:27], a[72:75], v[96:99]
    ds_read_b128 v[20:23], v1 offset:57856
    v_cvt_pk_bf16_f32 v122, v72, v73
    v_mfma_f32_16x16x32_bf16 v[100:103], v[24:27], a[76:79], v[100:103]
    v_cvt_pk_bf16_f32 v123, v74, v75
    v_mul_f32 v84, s72, v84
    v_mul_f32 v85, s72, v85
    v_mfma_f32_16x16x32_bf16 v[104:107], v[28:31], a[72:75], v[104:107]
    ds_read_b128 v[24:27], v2 offset:57344
    v_mul_f32 v86, s72, v86
    v_mfma_f32_16x16x32_bf16 v[108:111], v[28:31], a[76:79], v[108:111]
    v_mul_f32 v87, s72, v87
    v_exp_f32 v84, v84
    v_mfma_f32_16x16x32_bf16 v[96:99], v[32:35], a[80:83], v[96:99]
    ds_read_b128 v[28:31], v2 offset:57856
    v_exp_f32 v85, v85
    v_mfma_f32_16x16x32_bf16 v[100:103], v[32:35], a[84:87], v[100:103]
    v_exp_f32 v86, v86
    v_add_f32 v84, 1.0, v84
    s_waitcnt lgkmcnt(4)
    v_mfma_f32_16x16x32_bf16 v[104:107], v[36:39], a[80:83], v[104:107]
    ds_read_b128 v[32:35], v1 offset:61440
    v_exp_f32 v87, v87
    v_mfma_f32_16x16x32_bf16 v[108:111], v[36:39], a[84:87], v[108:111]
    v_add_f32 v85, 1.0, v85
    v_add_f32 v86, 1.0, v86
    v_add_f32 v87, 1.0, v87
    v_mfma_f32_16x16x32_bf16 v[96:99], v[40:43], a[88:91], v[96:99]
    ds_read_b128 v[36:39], v1 offset:61952
    v_rcp_f32 v84, v84
    v_mfma_f32_16x16x32_bf16 v[100:103], v[40:43], a[92:95], v[100:103]
    v_rcp_f32 v85, v85
    v_mul_f32 v80, v80, v84
    v_mfma_f32_16x16x32_bf16 v[104:107], v[44:47], a[88:91], v[104:107]
    ds_read_b128 v[40:43], v2 offset:61440
    v_rcp_f32 v86, v86
    v_mfma_f32_16x16x32_bf16 v[108:111], v[44:47], a[92:95], v[108:111]
    v_rcp_f32 v87, v87
    v_mul_f32 v81, v81, v85
    s_waitcnt lgkmcnt(3)
    v_mfma_f32_16x16x32_bf16 v[96:99], v[16:19], a[96:99], v[96:99]
    ds_read_b128 v[44:47], v2 offset:61952
    v_mul_f32 v82, v82, v86
    v_mfma_f32_16x16x32_bf16 v[100:103], v[16:19], a[100:103], v[100:103]
    v_mul_f32 v83, v83, v87
    v_cvt_pk_bf16_f32 v124, v80, v81
    v_cvt_pk_bf16_f32 v125, v82, v83
    v_mfma_f32_16x16x32_bf16 v[104:107], v[20:23], a[96:99], v[104:107]
    v_mul_f32 v92, s72, v92
    v_mul_f32 v93, s72, v93
    v_mul_f32 v94, s72, v94
    v_mfma_f32_16x16x32_bf16 v[108:111], v[20:23], a[100:103], v[108:111]
    v_mul_f32 v95, s72, v95
    v_exp_f32 v92, v92
    v_mfma_f32_16x16x32_bf16 v[96:99], v[24:27], a[104:107], v[96:99]
    v_exp_f32 v93, v93
    v_mfma_f32_16x16x32_bf16 v[100:103], v[24:27], a[108:111], v[100:103]
    v_exp_f32 v94, v94
    v_exp_f32 v95, v95
    v_mfma_f32_16x16x32_bf16 v[104:107], v[28:31], a[104:107], v[104:107]
    v_add_f32 v92, 1.0, v92
    v_add_f32 v93, 1.0, v93
    v_add_f32 v94, 1.0, v94
    v_mfma_f32_16x16x32_bf16 v[108:111], v[28:31], a[108:111], v[108:111]
    v_add_f32 v95, 1.0, v95
    v_rcp_f32 v92, v92
    s_waitcnt lgkmcnt(1)
    v_mfma_f32_16x16x32_bf16 v[96:99], v[32:35], a[112:115], v[96:99]
    v_rcp_f32 v93, v93
    v_mfma_f32_16x16x32_bf16 v[100:103], v[32:35], a[116:119], v[100:103]
    v_rcp_f32 v94, v94
    v_rcp_f32 v95, v95
    v_mfma_f32_16x16x32_bf16 v[104:107], v[36:39], a[112:115], v[104:107]
    v_mul_f32 v88, v88, v92
    v_mul_f32 v89, v89, v93
    v_mfma_f32_16x16x32_bf16 v[108:111], v[36:39], a[116:119], v[108:111]
    v_mul_f32 v90, v90, v94
    v_mul_f32 v91, v91, v95
    v_cvt_pk_bf16_f32 v126, v88, v89
    v_mfma_f32_16x16x32_bf16 v[96:99], v[40:43], a[120:123], v[96:99]
    v_cvt_pk_bf16_f32 v127, v90, v91
    v_mfma_f32_16x16x32_bf16 v[100:103], v[40:43], a[124:127], v[100:103]
    ds_write_b128 v6, v[112:115] offset:320
    s_waitcnt lgkmcnt(1)
    v_mfma_f32_16x16x32_bf16 v[104:107], v[44:47], a[120:123], v[104:107]
    ds_write_b128 v6, v[120:123] offset:384
    v_mfma_f32_16x16x32_bf16 v[108:111], v[44:47], a[124:127], v[108:111]
    ds_write_b128 v6, v[124:127] offset:0
    s_nop 1
    v_pk_mul_f32 v[100:101], v[100:101], s[72:73]
    v_pk_mul_f32 v[102:103], v[102:103], s[72:73]
    v_exp_f32 v100, v100
    v_exp_f32 v101, v101
    v_exp_f32 v102, v102
    v_exp_f32 v103, v103
    v_pk_add_f32 v[100:101], v[100:101], 1.0 op_sel_hi:[1,0]
    v_pk_add_f32 v[102:103], v[102:103], 1.0 op_sel_hi:[1,0]
    v_rcp_f32 v100, v100
    v_rcp_f32 v101, v101
    v_rcp_f32 v102, v102
    v_rcp_f32 v103, v103
    v_pk_mul_f32 v[96:97], v[96:97], v[100:101]
    v_pk_mul_f32 v[98:99], v[98:99], v[102:103]
    v_cvt_pk_bf16_f32 v100, v96, v97
    v_cvt_pk_bf16_f32 v101, v98, v99
    v_pk_mul_f32 v[108:109], v[108:109], s[72:73]
    v_pk_mul_f32 v[110:111], v[110:111], s[72:73]
    v_exp_f32 v108, v108
    v_exp_f32 v109, v109
    v_exp_f32 v110, v110
    v_exp_f32 v111, v111
    v_pk_add_f32 v[108:109], v[108:109], 1.0 op_sel_hi:[1,0]
    v_pk_add_f32 v[110:111], v[110:111], 1.0 op_sel_hi:[1,0]
    v_rcp_f32 v108, v108
    v_rcp_f32 v109, v109
    v_rcp_f32 v110, v110
    v_rcp_f32 v111, v111
    v_pk_mul_f32 v[104:105], v[104:105], v[108:109]
    v_pk_mul_f32 v[106:107], v[106:107], v[110:111]
    v_cvt_pk_bf16_f32 v102, v104, v105
    v_cvt_pk_bf16_f32 v103, v106, v107
    ds_write_b128 v6, v[100:103] offset:64
    s_waitcnt lgkmcnt(0)
    s_waitcnt vmcnt(8)
    s_barrier
    v_xor_b32 v1, 32, v9
    v_xor_b32 v2, 32, v10
    s_add_u32 m0, s51, 65536
    s_add_u32 s70, s35, 0
    buffer_load_dwordx4 v15, s[24:27], s70 offen lds
    ds_read_b64_tr_b16 a[0:1], v10 offset:0
    ds_read_b64_tr_b16 a[2:3], v10 offset:1024
    s_add_u32 m0, s51, 69632
    s_add_u32 s70, s35, 16384
    buffer_load_dwordx4 v15, s[24:27], s70 offen lds
    ds_read_b64_tr_b16 a[4:5], v2 offset:0
    ds_read_b64_tr_b16 a[6:7], v2 offset:1024
    s_add_u32 m0, s51, 73728
    s_add_u32 s70, s35, 32768
    buffer_load_dwordx4 v15, s[24:27], s70 offen lds
    ds_read_b64_tr_b16 a[8:9], v10 offset:8192
    ds_read_b64_tr_b16 a[10:11], v10 offset:9216
    s_add_u32 m0, s51, 77824
    s_add_u32 s70, s35, 49152
    buffer_load_dwordx4 v15, s[24:27], s70 offen lds
    ds_read_b64_tr_b16 a[12:13], v2 offset:8192
    ds_read_b64_tr_b16 a[14:15], v2 offset:9216
    s_add_u32 m0, s51, 81920
    s_add_u32 s70, s35, 65536
    buffer_load_dwordx4 v15, s[24:27], s70 offen lds
    ds_read_b64_tr_b16 a[16:17], v10 offset:16384
    ds_read_b64_tr_b16 a[18:19], v10 offset:17408
    s_add_u32 m0, s51, 86016
    s_add_u32 s70, s35, 81920
    buffer_load_dwordx4 v15, s[24:27], s70 offen lds
    ds_read_b64_tr_b16 a[20:21], v2 offset:16384
    ds_read_b64_tr_b16 a[22:23], v2 offset:17408
    s_add_u32 m0, s51, 90112
    s_add_u32 s70, s35, 98304
    buffer_load_dwordx4 v15, s[24:27], s70 offen lds
    ds_read_b64_tr_b16 a[24:25], v10 offset:24576
    ds_read_b64_tr_b16 a[26:27], v10 offset:25600
    s_add_u32 m0, s51, 94208
    s_add_u32 s70, s35, 114688
    buffer_load_dwordx4 v15, s[24:27], s70 offen lds
    ds_read_b64_tr_b16 a[28:29], v2 offset:24576
    ds_read_b64_tr_b16 a[30:31], v2 offset:25600
    ds_read_b64_tr_b16 a[32:33], v10 offset:32768
    ds_read_b64_tr_b16 a[34:35], v10 offset:33792
    ds_read_b64_tr_b16 a[36:37], v2 offset:32768
    ds_read_b64_tr_b16 a[38:39], v2 offset:33792
    ds_read_b64_tr_b16 a[40:41], v10 offset:40960
    ds_read_b64_tr_b16 a[42:43], v10 offset:41984
    ds_read_b64_tr_b16 a[44:45], v2 offset:40960
    ds_read_b64_tr_b16 a[46:47], v2 offset:41984
    ds_read_b64_tr_b16 a[48:49], v10 offset:49152
    ds_read_b64_tr_b16 a[50:51], v10 offset:50176
    ds_read_b64_tr_b16 a[52:53], v2 offset:49152
    ds_read_b64_tr_b16 a[54:55], v2 offset:50176
    ds_read_b64_tr_b16 a[56:57], v10 offset:57344
    ds_read_b64_tr_b16 a[58:59], v10 offset:58368
    ds_read_b64_tr_b16 a[60:61], v2 offset:57344
    ds_read_b64_tr_b16 a[62:63], v2 offset:58368
    s_waitcnt lgkmcnt(0)
    s_waitcnt vmcnt(0)
    s_barrier
    ds_read_b64_tr_b16 a[64:65], v9 offset:0
    ds_read_b64_tr_b16 a[66:67], v9 offset:1024
    ds_read_b64_tr_b16 a[68:69], v1 offset:0
    ds_read_b64_tr_b16 a[70:71], v1 offset:1024
    ds_read_b64_tr_b16 a[72:73], v9 offset:8192
    ds_read_b64_tr_b16 a[74:75], v9 offset:9216
    ds_read_b64_tr_b16 a[76:77], v1 offset:8192
    ds_read_b64_tr_b16 a[78:79], v1 offset:9216
    ds_read_b64_tr_b16 a[80:81], v9 offset:16384
    ds_read_b64_tr_b16 a[82:83], v9 offset:17408
    ds_read_b64_tr_b16 a[84:85], v1 offset:16384
    ds_read_b64_tr_b16 a[86:87], v1 offset:17408
    ds_read_b64_tr_b16 a[88:89], v9 offset:24576
    ds_read_b64_tr_b16 a[90:91], v9 offset:25600
    ds_read_b64_tr_b16 a[92:93], v1 offset:24576
    ds_read_b64_tr_b16 a[94:95], v1 offset:25600
    ds_read_b64_tr_b16 a[96:97], v9 offset:32768
    ds_read_b64_tr_b16 a[98:99], v9 offset:33792
    ds_read_b64_tr_b16 a[100:101], v1 offset:32768
    ds_read_b64_tr_b16 a[102:103], v1 offset:33792
    ds_read_b64_tr_b16 a[104:105], v9 offset:40960
    ds_read_b64_tr_b16 a[106:107], v9 offset:41984
    ds_read_b64_tr_b16 a[108:109], v1 offset:40960
    ds_read_b64_tr_b16 a[110:111], v1 offset:41984
    ds_read_b64_tr_b16 a[112:113], v9 offset:49152
    ds_read_b64_tr_b16 a[114:115], v9 offset:50176
    ds_read_b64_tr_b16 a[116:117], v1 offset:49152
    ds_read_b64_tr_b16 a[118:119], v1 offset:50176
    ds_read_b64_tr_b16 a[120:121], v9 offset:57344
    ds_read_b64_tr_b16 a[122:123], v9 offset:58368
    ds_read_b64_tr_b16 a[124:125], v1 offset:57344
    ds_read_b64_tr_b16 a[126:127], v1 offset:58368
    s_waitcnt lgkmcnt(0)
    s_barrier
    ds_read_b128 v[16:19], v8 offset:0
    ds_read_b128 v[20:23], v8 offset:256
    ds_read_b128 v[24:27], v8 offset:512
    ds_read_b128 v[28:31], v8 offset:768
    ds_read_b128 v[32:35], v8 offset:4096
    ds_read_b128 v[36:39], v8 offset:4352
    ds_read_b128 v[40:43], v8 offset:4608
    s_waitcnt lgkmcnt(6)
    v_mfma_f32_16x16x32_bf16 v[48:51], a[0:3], v[16:19], 0
    ds_read_b128 v[44:47], v8 offset:4864
    v_mfma_f32_16x16x32_bf16 v[52:55], a[4:7], v[16:19], 0
    s_waitcnt lgkmcnt(6)
    v_mfma_f32_16x16x32_bf16 v[56:59], a[0:3], v[20:23], 0
    ds_read_b128 v[16:19], v8 offset:8192
    v_mfma_f32_16x16x32_bf16 v[60:63], a[4:7], v[20:23], 0
    s_waitcnt lgkmcnt(6)
    v_mfma_f32_16x16x32_bf16 v[64:67], a[0:3], v[24:27], 0
    ds_read_b128 v[20:23], v8 offset:8448
    v_mfma_f32_16x16x32_bf16 v[68:71], a[4:7], v[24:27], 0
    s_waitcnt lgkmcnt(6)
    v_mfma_f32_16x16x32_bf16 v[72:75], a[0:3], v[28:31], 0
    ds_read_b128 v[24:27], v8 offset:8704
    v_mfma_f32_16x16x32_bf16 v[76:79], a[4:7], v[28:31], 0
    s_waitcnt lgkmcnt(6)
    v_mfma_f32_16x16x32_bf16 v[48:51], a[8:11], v[32:35], v[48:51]
    ds_read_b128 v[28:31], v8 offset:8960
    v_mfma_f32_16x16x32_bf16 v[52:55], a[12:15], v[32:35], v[52:55]
    s_waitcnt lgkmcnt(5)
    v_mfma_f32_16x16x32_bf16 v[56:59], a[8:11], v[36:39], v[56:59]
    ds_read_b128 v[32:35], v8 offset:12288
    v_mfma_f32_16x16x32_bf16 v[60:63], a[12:15], v[36:39], v[60:63]
    v_mfma_f32_16x16x32_bf16 v[64:67], a[8:11], v[40:43], v[64:67]
    ds_read_b128 v[36:39], v8 offset:12544
    v_mfma_f32_16x16x32_bf16 v[68:71], a[12:15], v[40:43], v[68:71]
    s_waitcnt lgkmcnt(5)
    v_mfma_f32_16x16x32_bf16 v[72:75], a[8:11], v[44:47], v[72:75]
    ds_read_b128 v[40:43], v8 offset:12800
    v_mfma_f32_16x16x32_bf16 v[76:79], a[12:15], v[44:47], v[76:79]
    v_mfma_f32_16x16x32_bf16 v[48:51], a[16:19], v[16:19], v[48:51]
    ds_read_b128 v[44:47], v8 offset:13056
    v_mfma_f32_16x16x32_bf16 v[52:55], a[20:23], v[16:19], v[52:55]
    s_waitcnt lgkmcnt(5)
    v_mfma_f32_16x16x32_bf16 v[56:59], a[16:19], v[20:23], v[56:59]
    v_mfma_f32_16x16x32_bf16 v[60:63], a[20:23], v[20:23], v[60:63]
    v_mfma_f32_16x16x32_bf16 v[64:67], a[16:19], v[24:27], v[64:67]
    s_barrier
    ds_read_b128 v[16:19], v8 offset:16384
    v_mfma_f32_16x16x32_bf16 v[68:71], a[20:23], v[24:27], v[68:71]
    ds_read_b128 v[20:23], v8 offset:16640
    s_waitcnt lgkmcnt(5)
    v_mfma_f32_16x16x32_bf16 v[72:75], a[16:19], v[28:31], v[72:75]
    ds_read_b128 v[24:27], v8 offset:16896
    v_mfma_f32_16x16x32_bf16 v[76:79], a[20:23], v[28:31], v[76:79]
    v_mfma_f32_16x16x32_bf16 v[48:51], a[24:27], v[32:35], v[48:51]
    ds_read_b128 v[28:31], v8 offset:17152
    v_mfma_f32_16x16x32_bf16 v[52:55], a[28:31], v[32:35], v[52:55]
    s_waitcnt lgkmcnt(5)
    v_mfma_f32_16x16x32_bf16 v[56:59], a[24:27], v[36:39], v[56:59]
    ds_read_b128 v[32:35], v8 offset:20480
    v_mfma_f32_16x16x32_bf16 v[60:63], a[28:31], v[36:39], v[60:63]
    v_mfma_f32_16x16x32_bf16 v[64:67], a[24:27], v[40:43], v[64:67]
    ds_read_b128 v[36:39], v8 offset:20736
    v_mfma_f32_16x16x32_bf16 v[68:71], a[28:31], v[40:43], v[68:71]
    s_waitcnt lgkmcnt(6)
    v_mfma_f32_16x16x32_bf16 v[72:75], a[24:27], v[44:47], v[72:75]
    ds_read_b128 v[40:43], v8 offset:20992
    v_mfma_f32_16x16x32_bf16 v[76:79], a[28:31], v[44:47], v[76:79]
    s_waitcnt lgkmcnt(5)
    v_mfma_f32_16x16x32_bf16 v[48:51], a[32:35], v[16:19], v[48:51]
    ds_read_b128 v[44:47], v8 offset:21248
    v_mfma_f32_16x16x32_bf16 v[52:55], a[36:39], v[16:19], v[52:55]
    v_mfma_f32_16x16x32_bf16 v[56:59], a[32:35], v[20:23], v[56:59]
    ds_read_b128 v[16:19], v8 offset:24576
    v_mfma_f32_16x16x32_bf16 v[60:63], a[36:39], v[20:23], v[60:63]
    s_waitcnt lgkmcnt(5)
    v_mfma_f32_16x16x32_bf16 v[64:67], a[32:35], v[24:27], v[64:67]
    ds_read_b128 v[20:23], v8 offset:24832
    v_mfma_f32_16x16x32_bf16 v[68:71], a[36:39], v[24:27], v[68:71]
    v_mfma_f32_16x16x32_bf16 v[72:75], a[32:35], v[28:31], v[72:75]
    ds_read_b128 v[24:27], v8 offset:25088
    v_mfma_f32_16x16x32_bf16 v[76:79], a[36:39], v[28:31], v[76:79]
    s_waitcnt lgkmcnt(5)
    v_mfma_f32_16x16x32_bf16 v[48:51], a[40:43], v[32:35], v[48:51]
    ds_read_b128 v[28:31], v8 offset:25344
    v_mfma_f32_16x16x32_bf16 v[52:55], a[44:47], v[32:35], v[52:55]
    v_mfma_f32_16x16x32_bf16 v[56:59], a[40:43], v[36:39], v[56:59]
    ds_read_b128 v[32:35], v8 offset:28672
    v_mfma_f32_16x16x32_bf16 v[60:63], a[44:47], v[36:39], v[60:63]
    s_waitcnt lgkmcnt(5)
    v_mfma_f32_16x16x32_bf16 v[64:67], a[40:43], v[40:43], v[64:67]
    ds_read_b128 v[36:39], v8 offset:28928
    v_mfma_f32_16x16x32_bf16 v[68:71], a[44:47], v[40:43], v[68:71]
    v_mfma_f32_16x16x32_bf16 v[72:75], a[40:43], v[44:47], v[72:75]
    ds_read_b128 v[40:43], v8 offset:29184
    v_mfma_f32_16x16x32_bf16 v[76:79], a[44:47], v[44:47], v[76:79]
    s_waitcnt lgkmcnt(5)
    v_mfma_f32_16x16x32_bf16 v[48:51], a[48:51], v[16:19], v[48:51]
    ds_read_b128 v[44:47], v8 offset:29440
    v_mfma_f32_16x16x32_bf16 v[52:55], a[52:55], v[16:19], v[52:55]
    v_mfma_f32_16x16x32_bf16 v[56:59], a[48:51], v[20:23], v[56:59]
    v_mfma_f32_16x16x32_bf16 v[60:63], a[52:55], v[20:23], v[60:63]
    s_waitcnt lgkmcnt(4)
    v_mfma_f32_16x16x32_bf16 v[64:67], a[48:51], v[24:27], v[64:67]
    s_barrier
    ds_read_b128 v[16:19], v8 offset:32768
    v_mfma_f32_16x16x32_bf16 v[68:71], a[52:55], v[24:27], v[68:71]
    ds_read_b128 v[20:23], v8 offset:33024
    v_mfma_f32_16x16x32_bf16 v[72:75], a[48:51], v[28:31], v[72:75]
    ds_read_b128 v[24:27], v8 offset:33280
    v_mfma_f32_16x16x32_bf16 v[76:79], a[52:55], v[28:31], v[76:79]
    s_waitcnt lgkmcnt(5)
    v_mfma_f32_16x16x32_bf16 v[48:51], a[56:59], v[32:35], v[48:51]
    ds_read_b128 v[28:31], v8 offset:33536
    v_mfma_f32_16x16x32_bf16 v[52:55], a[60:63], v[32:35], v[52:55]
    v_mfma_f32_16x16x32_bf16 v[56:59], a[56:59], v[36:39], v[56:59]
    ds_read_b128 v[32:35], v8 offset:36864
    v_mfma_f32_16x16x32_bf16 v[60:63], a[60:63], v[36:39], v[60:63]
    s_waitcnt lgkmcnt(5)
    v_mfma_f32_16x16x32_bf16 v[64:67], a[56:59], v[40:43], v[64:67]
    ds_read_b128 v[36:39], v8 offset:37120
    v_mfma_f32_16x16x32_bf16 v[68:71], a[60:63], v[40:43], v[68:71]
    v_mfma_f32_16x16x32_bf16 v[72:75], a[56:59], v[44:47], v[72:75]
    ds_read_b128 v[40:43], v8 offset:37376
    v_mfma_f32_16x16x32_bf16 v[76:79], a[60:63], v[44:47], v[76:79]
    s_waitcnt lgkmcnt(5)
    v_mfma_f32_16x16x32_bf16 v[48:51], a[64:67], v[16:19], v[48:51]
    ds_read_b128 v[44:47], v8 offset:37632
    v_mfma_f32_16x16x32_bf16 v[52:55], a[68:71], v[16:19], v[52:55]
    v_mfma_f32_16x16x32_bf16 v[56:59], a[64:67], v[20:23], v[56:59]
    ds_read_b128 v[16:19], v8 offset:40960
    v_mfma_f32_16x16x32_bf16 v[60:63], a[68:71], v[20:23], v[60:63]
    s_waitcnt lgkmcnt(5)
    v_mfma_f32_16x16x32_bf16 v[64:67], a[64:67], v[24:27], v[64:67]
    ds_read_b128 v[20:23], v8 offset:41216
    v_mfma_f32_16x16x32_bf16 v[68:71], a[68:71], v[24:27], v[68:71]
    v_mfma_f32_16x16x32_bf16 v[72:75], a[64:67], v[28:31], v[72:75]
    ds_read_b128 v[24:27], v8 offset:41472
    v_mfma_f32_16x16x32_bf16 v[76:79], a[68:71], v[28:31], v[76:79]
    s_waitcnt lgkmcnt(5)
    v_mfma_f32_16x16x32_bf16 v[48:51], a[72:75], v[32:35], v[48:51]
    ds_read_b128 v[28:31], v8 offset:41728
    v_mfma_f32_16x16x32_bf16 v[52:55], a[76:79], v[32:35], v[52:55]
    v_mfma_f32_16x16x32_bf16 v[56:59], a[72:75], v[36:39], v[56:59]
    ds_read_b128 v[32:35], v8 offset:45056
    v_mfma_f32_16x16x32_bf16 v[60:63], a[76:79], v[36:39], v[60:63]
    s_waitcnt lgkmcnt(5)
    v_mfma_f32_16x16x32_bf16 v[64:67], a[72:75], v[40:43], v[64:67]
    ds_read_b128 v[36:39], v8 offset:45312
    v_mfma_f32_16x16x32_bf16 v[68:71], a[76:79], v[40:43], v[68:71]
    v_mfma_f32_16x16x32_bf16 v[72:75], a[72:75], v[44:47], v[72:75]
    ds_read_b128 v[40:43], v8 offset:45568
    v_mfma_f32_16x16x32_bf16 v[76:79], a[76:79], v[44:47], v[76:79]
    s_waitcnt lgkmcnt(5)
    v_mfma_f32_16x16x32_bf16 v[48:51], a[80:83], v[16:19], v[48:51]
    ds_read_b128 v[44:47], v8 offset:45824
    v_mfma_f32_16x16x32_bf16 v[52:55], a[84:87], v[16:19], v[52:55]
    v_mfma_f32_16x16x32_bf16 v[56:59], a[80:83], v[20:23], v[56:59]
    v_mfma_f32_16x16x32_bf16 v[60:63], a[84:87], v[20:23], v[60:63]
    s_waitcnt lgkmcnt(4)
    v_mfma_f32_16x16x32_bf16 v[64:67], a[80:83], v[24:27], v[64:67]
    s_barrier
    ds_read_b128 v[16:19], v8 offset:49152
    v_mfma_f32_16x16x32_bf16 v[68:71], a[84:87], v[24:27], v[68:71]
    ds_read_b128 v[20:23], v8 offset:49408
    v_mfma_f32_16x16x32_bf16 v[72:75], a[80:83], v[28:31], v[72:75]
    ds_read_b128 v[24:27], v8 offset:49664
    v_mfma_f32_16x16x32_bf16 v[76:79], a[84:87], v[28:31], v[76:79]
    s_waitcnt lgkmcnt(5)
    v_mfma_f32_16x16x32_bf16 v[48:51], a[88:91], v[32:35], v[48:51]
    ds_read_b128 v[28:31], v8 offset:49920
    v_mfma_f32_16x16x32_bf16 v[52:55], a[92:95], v[32:35], v[52:55]
    v_mfma_f32_16x16x32_bf16 v[56:59], a[88:91], v[36:39], v[56:59]
    ds_read_b128 v[32:35], v8 offset:53248
    v_mfma_f32_16x16x32_bf16 v[60:63], a[92:95], v[36:39], v[60:63]
    s_waitcnt lgkmcnt(5)
    v_mfma_f32_16x16x32_bf16 v[64:67], a[88:91], v[40:43], v[64:67]
    ds_read_b128 v[36:39], v8 offset:53504
    v_mfma_f32_16x16x32_bf16 v[68:71], a[92:95], v[40:43], v[68:71]
    v_mfma_f32_16x16x32_bf16 v[72:75], a[88:91], v[44:47], v[72:75]
    ds_read_b128 v[40:43], v8 offset:53760
    v_mfma_f32_16x16x32_bf16 v[76:79], a[92:95], v[44:47], v[76:79]
    s_waitcnt lgkmcnt(5)
    v_mfma_f32_16x16x32_bf16 v[48:51], a[96:99], v[16:19], v[48:51]
    ds_read_b128 v[44:47], v8 offset:54016
    v_mfma_f32_16x16x32_bf16 v[52:55], a[100:103], v[16:19], v[52:55]
    v_mfma_f32_16x16x32_bf16 v[56:59], a[96:99], v[20:23], v[56:59]
    ds_read_b128 v[16:19], v8 offset:57344
    v_mfma_f32_16x16x32_bf16 v[60:63], a[100:103], v[20:23], v[60:63]
    s_waitcnt lgkmcnt(5)
    v_mfma_f32_16x16x32_bf16 v[64:67], a[96:99], v[24:27], v[64:67]
    ds_read_b128 v[20:23], v8 offset:57600
    v_mfma_f32_16x16x32_bf16 v[68:71], a[100:103], v[24:27], v[68:71]
    v_mfma_f32_16x16x32_bf16 v[72:75], a[96:99], v[28:31], v[72:75]
    ds_read_b128 v[24:27], v8 offset:57856
    v_mfma_f32_16x16x32_bf16 v[76:79], a[100:103], v[28:31], v[76:79]
    s_waitcnt lgkmcnt(5)
    v_mfma_f32_16x16x32_bf16 v[48:51], a[104:107], v[32:35], v[48:51]
    ds_read_b128 v[28:31], v8 offset:58112
    v_mfma_f32_16x16x32_bf16 v[52:55], a[108:111], v[32:35], v[52:55]
    v_mfma_f32_16x16x32_bf16 v[56:59], a[104:107], v[36:39], v[56:59]
    ds_read_b128 v[32:35], v8 offset:61440
    v_mfma_f32_16x16x32_bf16 v[60:63], a[108:111], v[36:39], v[60:63]
    s_waitcnt lgkmcnt(5)
    v_mfma_f32_16x16x32_bf16 v[64:67], a[104:107], v[40:43], v[64:67]
    ds_read_b128 v[36:39], v8 offset:61696
    v_mfma_f32_16x16x32_bf16 v[68:71], a[108:111], v[40:43], v[68:71]
    v_mfma_f32_16x16x32_bf16 v[72:75], a[104:107], v[44:47], v[72:75]
    ds_read_b128 v[40:43], v8 offset:61952
    v_mfma_f32_16x16x32_bf16 v[76:79], a[108:111], v[44:47], v[76:79]
    s_waitcnt lgkmcnt(5)
    v_mfma_f32_16x16x32_bf16 v[48:51], a[112:115], v[16:19], v[48:51]
    ds_read_b128 v[44:47], v8 offset:62208
    v_mfma_f32_16x16x32_bf16 v[52:55], a[116:119], v[16:19], v[52:55]
    v_mfma_f32_16x16x32_bf16 v[56:59], a[112:115], v[20:23], v[56:59]
    v_mfma_f32_16x16x32_bf16 v[60:63], a[116:119], v[20:23], v[60:63]
    s_waitcnt lgkmcnt(4)
    v_mfma_f32_16x16x32_bf16 v[64:67], a[112:115], v[24:27], v[64:67]
    v_mfma_f32_16x16x32_bf16 v[68:71], a[116:119], v[24:27], v[68:71]
    v_mfma_f32_16x16x32_bf16 v[72:75], a[112:115], v[28:31], v[72:75]
    v_mfma_f32_16x16x32_bf16 v[76:79], a[116:119], v[28:31], v[76:79]
    s_waitcnt lgkmcnt(2)
    v_mfma_f32_16x16x32_bf16 v[48:51], a[120:123], v[32:35], v[48:51]
    v_mfma_f32_16x16x32_bf16 v[52:55], a[124:127], v[32:35], v[52:55]
    v_mfma_f32_16x16x32_bf16 v[56:59], a[120:123], v[36:39], v[56:59]
    v_mfma_f32_16x16x32_bf16 v[60:63], a[124:127], v[36:39], v[60:63]
    s_waitcnt lgkmcnt(0)
    v_mfma_f32_16x16x32_bf16 v[64:67], a[120:123], v[40:43], v[64:67]
    v_mfma_f32_16x16x32_bf16 v[68:71], a[124:127], v[40:43], v[68:71]
    v_mfma_f32_16x16x32_bf16 v[72:75], a[120:123], v[44:47], v[72:75]
    v_mfma_f32_16x16x32_bf16 v[76:79], a[124:127], v[44:47], v[76:79]
    v_cvt_pk_bf16_f32 v112, v48, v49
    v_cvt_pk_bf16_f32 v113, v50, v51
    v_cvt_pk_bf16_f32 v114, v52, v53
    v_cvt_pk_bf16_f32 v115, v54, v55
    v_cvt_pk_bf16_f32 v116, v56, v57
    v_cvt_pk_bf16_f32 v117, v58, v59
    v_cvt_pk_bf16_f32 v118, v60, v61
    v_cvt_pk_bf16_f32 v119, v62, v63
    v_cvt_pk_bf16_f32 v120, v64, v65
    v_cvt_pk_bf16_f32 v121, v66, v67
    v_cvt_pk_bf16_f32 v122, v68, v69
    v_cvt_pk_bf16_f32 v123, v70, v71
    v_cvt_pk_bf16_f32 v124, v72, v73
    v_cvt_pk_bf16_f32 v125, v74, v75
    v_cvt_pk_bf16_f32 v126, v76, v77
    v_cvt_pk_bf16_f32 v127, v78, v79
    v_permlane16_swap_b32 v112, v114
    v_permlane16_swap_b32 v113, v115
    v_permlane16_swap_b32 v116, v118
    v_permlane16_swap_b32 v117, v119
    v_permlane16_swap_b32 v120, v122
    v_permlane16_swap_b32 v121, v123
    v_permlane16_swap_b32 v124, v126
    v_permlane16_swap_b32 v125, v127
    s_barrier
    ds_read_b128 v[16:19], v7 offset:0
    ds_read_b128 v[20:23], v7 offset:256
    ds_read_b128 v[24:27], v7 offset:512
    ds_read_b128 v[28:31], v7 offset:768
    ds_read_b128 v[32:35], v7 offset:4096
    ds_read_b128 v[36:39], v7 offset:4352
    ds_read_b128 v[40:43], v7 offset:4608
    s_waitcnt lgkmcnt(6)
    v_mfma_f32_16x16x32_bf16 v[80:83], a[0:3], v[16:19], 0
    ds_read_b128 v[44:47], v7 offset:4864
    v_mfma_f32_16x16x32_bf16 v[84:87], a[4:7], v[16:19], 0
    s_waitcnt lgkmcnt(6)
    v_mfma_f32_16x16x32_bf16 v[88:91], a[0:3], v[20:23], 0
    ds_read_b128 v[16:19], v7 offset:8192
    v_mfma_f32_16x16x32_bf16 v[92:95], a[4:7], v[20:23], 0
    s_waitcnt lgkmcnt(6)
    v_mfma_f32_16x16x32_bf16 v[96:99], a[0:3], v[24:27], 0
    ds_read_b128 v[20:23], v7 offset:8448
    v_mfma_f32_16x16x32_bf16 v[100:103], a[4:7], v[24:27], 0
    s_waitcnt lgkmcnt(6)
    v_mfma_f32_16x16x32_bf16 v[104:107], a[0:3], v[28:31], 0
    ds_read_b128 v[24:27], v7 offset:8704
    v_mfma_f32_16x16x32_bf16 v[108:111], a[4:7], v[28:31], 0
    s_waitcnt lgkmcnt(6)
    v_mfma_f32_16x16x32_bf16 v[80:83], a[8:11], v[32:35], v[80:83]
    ds_read_b128 v[28:31], v7 offset:8960
    v_mfma_f32_16x16x32_bf16 v[84:87], a[12:15], v[32:35], v[84:87]
    s_waitcnt lgkmcnt(5)
    v_mfma_f32_16x16x32_bf16 v[88:91], a[8:11], v[36:39], v[88:91]
    ds_read_b128 v[32:35], v7 offset:12288
    v_mfma_f32_16x16x32_bf16 v[92:95], a[12:15], v[36:39], v[92:95]
    v_mfma_f32_16x16x32_bf16 v[96:99], a[8:11], v[40:43], v[96:99]
    ds_read_b128 v[36:39], v7 offset:12544
    v_mfma_f32_16x16x32_bf16 v[100:103], a[12:15], v[40:43], v[100:103]
    s_waitcnt lgkmcnt(5)
    v_mfma_f32_16x16x32_bf16 v[104:107], a[8:11], v[44:47], v[104:107]
    ds_read_b128 v[40:43], v7 offset:12800
    v_mfma_f32_16x16x32_bf16 v[108:111], a[12:15], v[44:47], v[108:111]
    v_mfma_f32_16x16x32_bf16 v[80:83], a[16:19], v[16:19], v[80:83]
    ds_read_b128 v[44:47], v7 offset:13056
    v_mfma_f32_16x16x32_bf16 v[84:87], a[20:23], v[16:19], v[84:87]
    s_waitcnt lgkmcnt(5)
    v_mfma_f32_16x16x32_bf16 v[88:91], a[16:19], v[20:23], v[88:91]
    v_mfma_f32_16x16x32_bf16 v[92:95], a[20:23], v[20:23], v[92:95]
    v_mfma_f32_16x16x32_bf16 v[96:99], a[16:19], v[24:27], v[96:99]
    s_barrier
    ds_read_b128 v[16:19], v7 offset:16384
    v_mfma_f32_16x16x32_bf16 v[100:103], a[20:23], v[24:27], v[100:103]
    ds_read_b128 v[20:23], v7 offset:16640
    s_waitcnt lgkmcnt(5)
    v_mfma_f32_16x16x32_bf16 v[104:107], a[16:19], v[28:31], v[104:107]
    ds_read_b128 v[24:27], v7 offset:16896
    v_mfma_f32_16x16x32_bf16 v[108:111], a[20:23], v[28:31], v[108:111]
    v_mfma_f32_16x16x32_bf16 v[80:83], a[24:27], v[32:35], v[80:83]
    ds_read_b128 v[28:31], v7 offset:17152
    v_mfma_f32_16x16x32_bf16 v[84:87], a[28:31], v[32:35], v[84:87]
    s_waitcnt lgkmcnt(5)
    v_mfma_f32_16x16x32_bf16 v[88:91], a[24:27], v[36:39], v[88:91]
    ds_read_b128 v[32:35], v7 offset:20480
    v_mfma_f32_16x16x32_bf16 v[92:95], a[28:31], v[36:39], v[92:95]
    v_mfma_f32_16x16x32_bf16 v[96:99], a[24:27], v[40:43], v[96:99]
    ds_read_b128 v[36:39], v7 offset:20736
    v_mfma_f32_16x16x32_bf16 v[100:103], a[28:31], v[40:43], v[100:103]
    s_waitcnt lgkmcnt(6)
    v_mfma_f32_16x16x32_bf16 v[104:107], a[24:27], v[44:47], v[104:107]
    ds_read_b128 v[40:43], v7 offset:20992
    v_mfma_f32_16x16x32_bf16 v[108:111], a[28:31], v[44:47], v[108:111]
    s_waitcnt lgkmcnt(5)
    v_mfma_f32_16x16x32_bf16 v[80:83], a[32:35], v[16:19], v[80:83]
    ds_read_b128 v[44:47], v7 offset:21248
    v_mfma_f32_16x16x32_bf16 v[84:87], a[36:39], v[16:19], v[84:87]
    v_mfma_f32_16x16x32_bf16 v[88:91], a[32:35], v[20:23], v[88:91]
    ds_read_b128 v[16:19], v7 offset:24576
    v_mfma_f32_16x16x32_bf16 v[92:95], a[36:39], v[20:23], v[92:95]
    s_waitcnt lgkmcnt(5)
    v_mfma_f32_16x16x32_bf16 v[96:99], a[32:35], v[24:27], v[96:99]
    ds_read_b128 v[20:23], v7 offset:24832
    v_mfma_f32_16x16x32_bf16 v[100:103], a[36:39], v[24:27], v[100:103]
    v_mfma_f32_16x16x32_bf16 v[104:107], a[32:35], v[28:31], v[104:107]
    ds_read_b128 v[24:27], v7 offset:25088
    v_mfma_f32_16x16x32_bf16 v[108:111], a[36:39], v[28:31], v[108:111]
    s_waitcnt lgkmcnt(5)
    v_mfma_f32_16x16x32_bf16 v[80:83], a[40:43], v[32:35], v[80:83]
    ds_read_b128 v[28:31], v7 offset:25344
    v_mfma_f32_16x16x32_bf16 v[84:87], a[44:47], v[32:35], v[84:87]
    v_mfma_f32_16x16x32_bf16 v[88:91], a[40:43], v[36:39], v[88:91]
    ds_read_b128 v[32:35], v7 offset:28672
    v_mfma_f32_16x16x32_bf16 v[92:95], a[44:47], v[36:39], v[92:95]
    s_waitcnt lgkmcnt(5)
    v_mfma_f32_16x16x32_bf16 v[96:99], a[40:43], v[40:43], v[96:99]
    ds_read_b128 v[36:39], v7 offset:28928
    v_mfma_f32_16x16x32_bf16 v[100:103], a[44:47], v[40:43], v[100:103]
    v_mfma_f32_16x16x32_bf16 v[104:107], a[40:43], v[44:47], v[104:107]
    ds_read_b128 v[40:43], v7 offset:29184
    v_mfma_f32_16x16x32_bf16 v[108:111], a[44:47], v[44:47], v[108:111]
    s_waitcnt lgkmcnt(5)
    v_mfma_f32_16x16x32_bf16 v[80:83], a[48:51], v[16:19], v[80:83]
    ds_read_b128 v[44:47], v7 offset:29440
    v_mfma_f32_16x16x32_bf16 v[84:87], a[52:55], v[16:19], v[84:87]
    v_mfma_f32_16x16x32_bf16 v[88:91], a[48:51], v[20:23], v[88:91]
    v_mfma_f32_16x16x32_bf16 v[92:95], a[52:55], v[20:23], v[92:95]
    s_waitcnt lgkmcnt(4)
    v_mfma_f32_16x16x32_bf16 v[96:99], a[48:51], v[24:27], v[96:99]
    s_barrier
    ds_read_b128 v[16:19], v7 offset:32768
    v_mfma_f32_16x16x32_bf16 v[100:103], a[52:55], v[24:27], v[100:103]
    ds_read_b128 v[20:23], v7 offset:33024
    v_mfma_f32_16x16x32_bf16 v[104:107], a[48:51], v[28:31], v[104:107]
    ds_read_b128 v[24:27], v7 offset:33280
    v_mfma_f32_16x16x32_bf16 v[108:111], a[52:55], v[28:31], v[108:111]
    s_waitcnt lgkmcnt(5)
    v_mfma_f32_16x16x32_bf16 v[80:83], a[56:59], v[32:35], v[80:83]
    ds_read_b128 v[28:31], v7 offset:33536
    v_mfma_f32_16x16x32_bf16 v[84:87], a[60:63], v[32:35], v[84:87]
    v_mfma_f32_16x16x32_bf16 v[88:91], a[56:59], v[36:39], v[88:91]
    ds_read_b128 v[32:35], v7 offset:36864
    v_mfma_f32_16x16x32_bf16 v[92:95], a[60:63], v[36:39], v[92:95]
    s_waitcnt lgkmcnt(5)
    v_mfma_f32_16x16x32_bf16 v[96:99], a[56:59], v[40:43], v[96:99]
    ds_read_b128 v[36:39], v7 offset:37120
    v_mfma_f32_16x16x32_bf16 v[100:103], a[60:63], v[40:43], v[100:103]
    v_mfma_f32_16x16x32_bf16 v[104:107], a[56:59], v[44:47], v[104:107]
    ds_read_b128 v[40:43], v7 offset:37376
    v_mfma_f32_16x16x32_bf16 v[108:111], a[60:63], v[44:47], v[108:111]
    s_waitcnt lgkmcnt(5)
    v_mfma_f32_16x16x32_bf16 v[80:83], a[64:67], v[16:19], v[80:83]
    ds_read_b128 v[44:47], v7 offset:37632
    v_mfma_f32_16x16x32_bf16 v[84:87], a[68:71], v[16:19], v[84:87]
    v_mfma_f32_16x16x32_bf16 v[88:91], a[64:67], v[20:23], v[88:91]
    ds_read_b128 v[16:19], v7 offset:40960
    v_mfma_f32_16x16x32_bf16 v[92:95], a[68:71], v[20:23], v[92:95]
    s_waitcnt lgkmcnt(5)
    v_mfma_f32_16x16x32_bf16 v[96:99], a[64:67], v[24:27], v[96:99]
    ds_read_b128 v[20:23], v7 offset:41216
    v_mfma_f32_16x16x32_bf16 v[100:103], a[68:71], v[24:27], v[100:103]
    v_mfma_f32_16x16x32_bf16 v[104:107], a[64:67], v[28:31], v[104:107]
    ds_read_b128 v[24:27], v7 offset:41472
    v_mfma_f32_16x16x32_bf16 v[108:111], a[68:71], v[28:31], v[108:111]
    s_waitcnt lgkmcnt(5)
    v_mfma_f32_16x16x32_bf16 v[80:83], a[72:75], v[32:35], v[80:83]
    ds_read_b128 v[28:31], v7 offset:41728
    v_mfma_f32_16x16x32_bf16 v[84:87], a[76:79], v[32:35], v[84:87]
    v_mfma_f32_16x16x32_bf16 v[88:91], a[72:75], v[36:39], v[88:91]
    ds_read_b128 v[32:35], v7 offset:45056
    v_mfma_f32_16x16x32_bf16 v[92:95], a[76:79], v[36:39], v[92:95]
    s_waitcnt lgkmcnt(5)
    v_mfma_f32_16x16x32_bf16 v[96:99], a[72:75], v[40:43], v[96:99]
    ds_read_b128 v[36:39], v7 offset:45312
    v_mfma_f32_16x16x32_bf16 v[100:103], a[76:79], v[40:43], v[100:103]
    v_mfma_f32_16x16x32_bf16 v[104:107], a[72:75], v[44:47], v[104:107]
    ds_read_b128 v[40:43], v7 offset:45568
    v_mfma_f32_16x16x32_bf16 v[108:111], a[76:79], v[44:47], v[108:111]
    s_waitcnt lgkmcnt(5)
    v_mfma_f32_16x16x32_bf16 v[80:83], a[80:83], v[16:19], v[80:83]
    ds_read_b128 v[44:47], v7 offset:45824
    v_mfma_f32_16x16x32_bf16 v[84:87], a[84:87], v[16:19], v[84:87]
    v_mfma_f32_16x16x32_bf16 v[88:91], a[80:83], v[20:23], v[88:91]
    v_mfma_f32_16x16x32_bf16 v[92:95], a[84:87], v[20:23], v[92:95]
    s_waitcnt lgkmcnt(4)
    v_mfma_f32_16x16x32_bf16 v[96:99], a[80:83], v[24:27], v[96:99]
    s_barrier
    ds_read_b128 v[16:19], v7 offset:49152
    v_mfma_f32_16x16x32_bf16 v[100:103], a[84:87], v[24:27], v[100:103]
    ds_read_b128 v[20:23], v7 offset:49408
    v_mfma_f32_16x16x32_bf16 v[104:107], a[80:83], v[28:31], v[104:107]
    ds_read_b128 v[24:27], v7 offset:49664
    v_mfma_f32_16x16x32_bf16 v[108:111], a[84:87], v[28:31], v[108:111]
    s_waitcnt lgkmcnt(5)
    v_mfma_f32_16x16x32_bf16 v[80:83], a[88:91], v[32:35], v[80:83]
    ds_read_b128 v[28:31], v7 offset:49920
    v_mfma_f32_16x16x32_bf16 v[84:87], a[92:95], v[32:35], v[84:87]
    ds_write_b128 v11, v[112:115] offset:0
    v_mfma_f32_16x16x32_bf16 v[88:91], a[88:91], v[36:39], v[88:91]
    ds_read_b128 v[32:35], v7 offset:53248
    v_mfma_f32_16x16x32_bf16 v[92:95], a[92:95], v[36:39], v[92:95]
    ds_write_b128 v11, v[116:119] offset:4096
    s_waitcnt lgkmcnt(7)
    v_mfma_f32_16x16x32_bf16 v[96:99], a[88:91], v[40:43], v[96:99]
    ds_read_b128 v[36:39], v7 offset:53504
    v_mfma_f32_16x16x32_bf16 v[100:103], a[92:95], v[40:43], v[100:103]
    ds_write_b128 v11, v[120:123] offset:8192
    v_mfma_f32_16x16x32_bf16 v[104:107], a[88:91], v[44:47], v[104:107]
    ds_read_b128 v[40:43], v7 offset:53760
    v_mfma_f32_16x16x32_bf16 v[108:111], a[92:95], v[44:47], v[108:111]
    ds_write_b128 v11, v[124:127] offset:12288
    s_waitcnt lgkmcnt(8)
    v_mfma_f32_16x16x32_bf16 v[80:83], a[96:99], v[16:19], v[80:83]
    ds_read_b128 v[44:47], v7 offset:54016
    v_mfma_f32_16x16x32_bf16 v[84:87], a[100:103], v[16:19], v[84:87]
    v_mfma_f32_16x16x32_bf16 v[88:91], a[96:99], v[20:23], v[88:91]
    ds_read_b128 v[16:19], v7 offset:57344
    s_waitcnt lgkmcnt(2)
    v_mfma_f32_16x16x32_bf16 v[92:95], a[100:103], v[20:23], v[92:95]
    s_barrier
    v_mfma_f32_16x16x32_bf16 v[96:99], a[96:99], v[24:27], v[96:99]
    ds_read_b128 v[20:23], v7 offset:57600
    v_mfma_f32_16x16x32_bf16 v[100:103], a[100:103], v[24:27], v[100:103]
    v_mfma_f32_16x16x32_bf16 v[104:107], a[96:99], v[28:31], v[104:107]
    ds_read_b128 v[24:27], v7 offset:57856
    v_mfma_f32_16x16x32_bf16 v[108:111], a[100:103], v[28:31], v[108:111]
    v_mfma_f32_16x16x32_bf16 v[80:83], a[104:107], v[32:35], v[80:83]
    ds_read_b128 v[28:31], v7 offset:58112
    v_mfma_f32_16x16x32_bf16 v[84:87], a[108:111], v[32:35], v[84:87]
    v_mfma_f32_16x16x32_bf16 v[88:91], a[104:107], v[36:39], v[88:91]
    ds_read_b128 v[32:35], v7 offset:61440
    v_mfma_f32_16x16x32_bf16 v[92:95], a[108:111], v[36:39], v[92:95]
    v_mfma_f32_16x16x32_bf16 v[96:99], a[104:107], v[40:43], v[96:99]
    ds_read_b128 v[36:39], v7 offset:61696
    v_mfma_f32_16x16x32_bf16 v[100:103], a[108:111], v[40:43], v[100:103]
    s_waitcnt lgkmcnt(5)
    v_mfma_f32_16x16x32_bf16 v[104:107], a[104:107], v[44:47], v[104:107]
    ds_read_b128 v[40:43], v7 offset:61952
    v_mfma_f32_16x16x32_bf16 v[108:111], a[108:111], v[44:47], v[108:111]
    v_mfma_f32_16x16x32_bf16 v[80:83], a[112:115], v[16:19], v[80:83]
    ds_read_b128 v[44:47], v7 offset:62208
    v_mfma_f32_16x16x32_bf16 v[84:87], a[116:119], v[16:19], v[84:87]
    s_waitcnt lgkmcnt(5)
    v_mfma_f32_16x16x32_bf16 v[88:91], a[112:115], v[20:23], v[88:91]
    v_mfma_f32_16x16x32_bf16 v[92:95], a[116:119], v[20:23], v[92:95]
    v_mfma_f32_16x16x32_bf16 v[96:99], a[112:115], v[24:27], v[96:99]
    v_mfma_f32_16x16x32_bf16 v[100:103], a[116:119], v[24:27], v[100:103]
    s_waitcnt lgkmcnt(3)
    v_mfma_f32_16x16x32_bf16 v[104:107], a[112:115], v[28:31], v[104:107]
    v_mfma_f32_16x16x32_bf16 v[108:111], a[116:119], v[28:31], v[108:111]
    v_mfma_f32_16x16x32_bf16 v[80:83], a[120:123], v[32:35], v[80:83]
    v_mfma_f32_16x16x32_bf16 v[84:87], a[124:127], v[32:35], v[84:87]
    s_waitcnt lgkmcnt(1)
    v_mfma_f32_16x16x32_bf16 v[88:91], a[120:123], v[36:39], v[88:91]
    v_mfma_f32_16x16x32_bf16 v[92:95], a[124:127], v[36:39], v[92:95]
    v_mfma_f32_16x16x32_bf16 v[96:99], a[120:123], v[40:43], v[96:99]
    v_mfma_f32_16x16x32_bf16 v[100:103], a[124:127], v[40:43], v[100:103]
    s_waitcnt lgkmcnt(0)
    v_mfma_f32_16x16x32_bf16 v[104:107], a[120:123], v[44:47], v[104:107]
    v_mfma_f32_16x16x32_bf16 v[108:111], a[124:127], v[44:47], v[108:111]
    v_cvt_pk_bf16_f32 v112, v80, v81
    v_cvt_pk_bf16_f32 v113, v82, v83
    v_cvt_pk_bf16_f32 v114, v84, v85
    v_cvt_pk_bf16_f32 v115, v86, v87
    v_cvt_pk_bf16_f32 v116, v88, v89
    v_cvt_pk_bf16_f32 v117, v90, v91
    v_cvt_pk_bf16_f32 v118, v92, v93
    v_cvt_pk_bf16_f32 v119, v94, v95
    v_cvt_pk_bf16_f32 v120, v96, v97
    v_cvt_pk_bf16_f32 v121, v98, v99
    v_cvt_pk_bf16_f32 v122, v100, v101
    v_cvt_pk_bf16_f32 v123, v102, v103
    v_cvt_pk_bf16_f32 v124, v104, v105
    v_cvt_pk_bf16_f32 v125, v106, v107
    v_cvt_pk_bf16_f32 v126, v108, v109
    v_cvt_pk_bf16_f32 v127, v110, v111
    v_permlane16_swap_b32 v112, v114
    v_permlane16_swap_b32 v113, v115
    ds_write_b128 v11, v[112:115] offset:16384
    v_permlane16_swap_b32 v116, v118
    v_permlane16_swap_b32 v117, v119
    ds_write_b128 v11, v[116:119] offset:20480
    v_permlane16_swap_b32 v120, v122
    v_permlane16_swap_b32 v121, v123
    ds_write_b128 v11, v[120:123] offset:24576
    v_permlane16_swap_b32 v124, v126
    v_permlane16_swap_b32 v125, v127
    ds_write_b128 v11, v[124:127] offset:28672
    s_waitcnt lgkmcnt(0)
    s_barrier
    ds_read_b128 v[16:19], v13 offset:16384
    v_xor_b32 v13, 64, v13
    ds_read_b128 v[20:23], v13 offset:17408
    v_xor_b32 v13, 64, v13
    s_mov_b32 s70, 131072
    s_waitcnt lgkmcnt(1)
    buffer_store_dwordx4 v[16:19], v14, s[28:31], s70 offen sc1
    s_mov_b32 s70, 135168
    s_waitcnt lgkmcnt(0)
    buffer_store_dwordx4 v[20:23], v14, s[28:31], s70 offen sc1
    s_branch L_end
L_slow_ack:
    s_mov_b32 s7, 50000
L_spin_ack:
    s_sleep 8
    global_load_dword v31, v28, s[42:43] sc1
    s_sub_u32 s7, s7, 1
    s_cmp_eq_u32 s7, 0
    s_cbranch_scc1 L_give_ack
    s_waitcnt vmcnt(0)
    v_cmp_ne_u32 vcc, 1, v31
    s_nop 1
    s_cmp_lg_u32 vcc_lo, 0
    s_cbranch_scc1 L_spin_ack
L_give_ack:
    s_waitcnt vmcnt(0)
    s_branch L_ok_ack
L_slow_p0:
    s_mov_b32 s7, 50000
L_spin_p0:
    s_sleep 8
    s_mov_b32 exec_lo, -1
    s_mov_b32 exec_hi, 0
    buffer_load_dword v125, v29, s[20:23], 0 offen sc1
    s_mov_b64 exec, -1
    s_sub_u32 s7, s7, 1
    s_cmp_eq_u32 s7, 0
    s_cbranch_scc1 L_give_p0
    s_waitcnt vmcnt(0)
    v_cmp_ne_u32 vcc, 1, v125
    s_nop 1
    s_cmp_lg_u32 vcc_lo, 0
    s_cbranch_scc1 L_spin_p0
L_give_p0:
    s_waitcnt vmcnt(0)
    s_branch L_ok_p0
L_slow_p1:
    s_mov_b32 s7, 50000
L_spin_p1:
    s_sleep 8
    s_mov_b32 exec_lo, 0
    s_mov_b32 exec_hi, -1
    buffer_load_dword v125, v29, s[20:23], 0 offen sc1
    s_mov_b64 exec, -1
    s_sub_u32 s7, s7, 1
    s_cmp_eq_u32 s7, 0
    s_cbranch_scc1 L_give_p1
    s_waitcnt vmcnt(0)
    v_cmp_ne_u32 vcc, 1, v125
    s_nop 1
    s_cmp_lg_u32 vcc_hi, 0
    s_cbranch_scc1 L_spin_p1
L_give_p1:
    s_waitcnt vmcnt(0)
    s_branch L_ok_p1
L_code_end:
.section .rodata,"a"
.p2align 6
.amdhsa_kernel standalone__conformer_conv_module__speech_kernel
  .amdhsa_next_free_vgpr 256
  .amdhsa_next_free_sgpr 102
  .amdhsa_accum_offset 128
  .amdhsa_group_segment_fixed_size 0
  .amdhsa_kernarg_size 56
  .amdhsa_user_sgpr_count 2
  .amdhsa_user_sgpr_kernarg_segment_ptr 1
  .amdhsa_system_sgpr_workgroup_id_x 1
.end_amdhsa_kernel
```
